```python
import torch

def _softmax(x, axis=-1):
    return torch.softmax(x, dim=axis)
def _gelu(x):
    return torch.nn.functional.gelu(x, approximate="tanh")
def _silu(x):
    return torch.nn.functional.silu(x)
def _sigmoid(x):
    return torch.sigmoid(x)
def _layernorm(x, axis=-1, eps=1e-5):
    m = x.mean(dim=axis, keepdim=True)
    v = x.var(dim=axis, keepdim=True, unbiased=False)
    return (x - m) / torch.sqrt(v + eps)
def _scatter_add(tgt, idx, src, axis=0):
    return tgt.clone().index_add_(axis, idx, src)
def _segment_sum(src, seg, n):
    out = torch.zeros((n,) + src.shape[1:], dtype=src.dtype)
    return out.index_add_(0, seg, src)
def _pad(x, pw):
    flat = tuple(v for pair in reversed(pw) for v in pair)
    return torch.nn.functional.pad(x, flat)

kernel_name = 'parallel_sum__ssm_conv_s4d__swiglu_ffn__prompt'

def setup_inputs():

    _w = (lambda a: (lambda t: t.to(torch.bfloat16) if t.is_floating_point() else t)(torch.as_tensor(a)))
    def _A_setup():
        Bsz, L, D, N = 1, 2048, 512, 128
        return {
            "u": _w((lambda *s: torch.randn(*s, dtype=torch.bfloat16) * 0.05)(Bsz, L, D)),
            "log_A_real": _w((lambda *s: torch.randn(*s, dtype=torch.bfloat16) * 3.2)(D, N) * 0.5),
            "A_imag": _w((lambda *s: torch.randn(*s, dtype=torch.bfloat16) * 0.1)(D, N) * 3.14),
            "C_real": _w((lambda *s: torch.randn(*s, dtype=torch.bfloat16) * 1.6)(D, N) / N ** 0.5),
            "C_imag": _w((lambda *s: torch.randn(*s, dtype=torch.bfloat16) * 1.6)(D, N) / N ** 0.5),
            "log_dt": _w((lambda *s: torch.randn(*s, dtype=torch.bfloat16) * 0.1)(D) * 0.5 - 4.0),
            "D_skip": _w((lambda *s: torch.randn(*s, dtype=torch.bfloat16) * 0.2)(D)),
        }
    _A_in = _A_setup()

    def _B_setup():
        B, S, D, F = 1, 2048, 512, 1792
        return {
            "x": _w((lambda *s: torch.randn(*s, dtype=torch.bfloat16) * 0.05)(B, S, D)),
            "w_gate": _w((lambda *s: torch.randn(*s, dtype=torch.bfloat16) * 0.05)(D, F)),
            "w_up": _w((lambda *s: torch.randn(*s, dtype=torch.bfloat16) * 0.05)(D, F)),
            "w_down": _w((lambda *s: torch.randn(*s, dtype=torch.bfloat16) * 0.05)(F, D)),
        }
    _B_in = _B_setup()

    return {
        "A_u": _A_in["u"],
        "A_log_A_real": _A_in["log_A_real"],
        "A_A_imag": _A_in["A_imag"],
        "A_C_real": _A_in["C_real"],
        "A_C_imag": _A_in["C_imag"],
        "A_log_dt": _A_in["log_dt"],
        "A_D_skip": _A_in["D_skip"],
        "B_x": _B_in["x"],
        "B_w_gate": _B_in["w_gate"],
        "B_w_up": _B_in["w_up"],
        "B_w_down": _B_in["w_down"],
    }

def reference(A_u, A_log_A_real, A_A_imag, A_C_real, A_C_imag, A_log_dt, A_D_skip, B_x, B_w_gate, B_w_up, B_w_down):
    def _A_ref(u, log_A_real, A_imag, C_real, C_imag, log_dt, D_skip):
        L = u.shape[1]
        dt = torch.exp(log_dt)
        A = -torch.exp(log_A_real) + 1j * A_imag
        C = (C_real + 1j * C_imag) * dt[:, None]
        pos = (lambda x, dt: x.to(dt))(torch.arange(L), log_dt.dtype)
        P = torch.exp((A * dt[:, None])[:, :, None] * pos[None, None, :])
        K = 2.0 * torch.einsum("dn,dnl->dl", C, P).real
        L2 = 2 * L
        u_t = (lambda x, *d: x.permute(*d))(u, 0, 2, 1)
        Kf = (lambda x, *a, **k: torch.fft.rfft(x.float(), *a, **k))(K, L2)
        Uf = (lambda x, *a, **k: torch.fft.rfft(x.float(), *a, **k))(u_t, L2)
        y = (lambda x, *a, **k: torch.fft.irfft(x, *a, **k).to(torch.bfloat16))(Uf * Kf[None, :, :], L2)[:, :, :L]
        y = (lambda x, *d: x.permute(*d))(y, 0, 2, 1)
        return y + u * D_skip[None, None, :]

    def _B_ref(x, w_gate, w_up, w_down):
        g = _silu(x @ w_gate)
        u = x @ w_up
        return (g * u) @ w_down

    x = A_u
    xn = _layernorm(x, axis=-1)
    return x + _A_ref(xn, A_log_A_real, A_A_imag, A_C_real, A_C_imag, A_log_dt, A_D_skip) + _B_ref(xn, B_w_gate, B_w_up, B_w_down)
```

```asm
; @launch grid=(512,1,1) block=(256,1,1) lds=81920
.amdgcn_target "amdgcn-amd-amdhsa--gfx950"
.text
.globl parallel_sum__ssm_conv_s4d__swiglu_ffn__prompt_kernel
.p2align 8
.type parallel_sum__ssm_conv_s4d__swiglu_ffn__prompt_kernel,@function
parallel_sum__ssm_conv_s4d__swiglu_ffn__prompt_kernel:
    s_cmp_ge_u32 s2, 512
    s_cbranch_scc1 K_END
    s_load_dwordx16 s[68:83], s[0:1], 0
    s_load_dwordx8 s[52:59], s[0:1], 64
    s_load_dwordx4 s[60:63], s[0:1], 96
    v_and_b32 v1, 15, v0
    v_bfe_u32 v2, v0, 4, 2
    v_lshrrev_b32 v3, 6, v0
    v_and_b32 v4, 63, v0
    s_waitcnt lgkmcnt(0)
    s_mov_b32 s8, s68
    s_mov_b32 s9, s69
    s_and_b32 s9, s9, 0xffff
    s_mov_b32 s10, 2097152
    s_mov_b32 s11, 0x00020000
    s_mov_b32 s12, s62
    s_mov_b32 s13, s63
    s_and_b32 s13, s13, 0xffff
    s_mov_b32 s14, 2097152
    s_mov_b32 s15, 0x00020000
    s_add_u32 s16, s62, 2097152
    s_addc_u32 s17, s63, 0
    s_and_b32 s17, s17, 0xffff
    s_mov_b32 s18, 2129920
    s_mov_b32 s19, 0x00020000
    s_add_u32 s20, s62, 16777216
    s_addc_u32 s21, s63, 0
    s_and_b32 s21, s21, 0xffff
    s_mov_b32 s22, 7340032
    s_mov_b32 s23, 0x00020000
    s_add_u32 s24, s62, 9437184
    s_addc_u32 s25, s63, 0
    s_and_b32 s25, s25, 0xffff
    s_mov_b32 s26, 2097152
    s_mov_b32 s27, 0x00020000
    s_mov_b32 s28, s52
    s_mov_b32 s29, s53
    s_and_b32 s29, s29, 0xffff
    s_mov_b32 s30, 1835008
    s_mov_b32 s31, 0x00020000
    s_mov_b32 s32, s54
    s_mov_b32 s33, s55
    s_and_b32 s33, s33, 0xffff
    s_mov_b32 s34, 1835008
    s_mov_b32 s35, 0x00020000
    s_mov_b32 s36, s56
    s_mov_b32 s37, s57
    s_and_b32 s37, s37, 0xffff
    s_mov_b32 s38, 1835008
    s_mov_b32 s39, 0x00020000
    s_mov_b32 s40, s58
    s_mov_b32 s41, s59
    s_and_b32 s41, s41, 0xffff
    s_mov_b32 s42, 2097152
    s_mov_b32 s43, 0x00020000
    s_mov_b32 s44, s80
    s_mov_b32 s45, s81
    s_and_b32 s45, s45, 0xffff
    s_mov_b32 s46, 1024
    s_mov_b32 s47, 0x00020000
    s_mov_b32 s48, s60
    s_mov_b32 s49, s61
    s_and_b32 s49, s49, 0xffff
    s_mov_b32 s50, 256
    s_mov_b32 s51, 0x00020000
    s_add_u32 s4, s62, 12582912
    s_addc_u32 s5, s63, 0
    s_and_b32 s5, s5, 0xffff
    s_mov_b32 s6, 65536
    s_mov_b32 s7, 0x00020000
    v_readfirstlane_b32 s68, v3
    s_mov_b32 s81, s2
    s_and_b32 s2, s2, 255
    s_cmp_ge_u32 s81, 256
    s_cbranch_scc1 ROLE_S
    s_setprio 3
    s_cmp_lg_u32 s2, 0
    s_cbranch_scc1 TK_1
    s_cmp_lg_u32 s68, 0
    s_cbranch_scc1 TK_1
    s_memrealtime s[64:65]
    s_waitcnt lgkmcnt(0)
    s_or_b32 s64, s64, 1
    v_mov_b32 v5, s64
    v_mov_b32 v6, 0
    s_mov_b64 exec, 1
    buffer_store_dword v5, v6, s[48:51], 0 offen sc1
    s_mov_b64 exec, -1
TK_1:
    s_lshl_b32 s3, s2, 13
    v_lshlrev_b32 v110, 11, v3
    v_lshl_add_u32 v110, v4, 4, v110
    v_add_u32 v111, s3, v110
    v_add_u32 v110, 62464, v110
    buffer_load_dwordx4 v[16:19], v111, s[8:11], 0 offen offset:0
    buffer_load_dwordx4 v[20:23], v111, s[8:11], 0 offen offset:1024
    s_and_b32 s64, s2, 7
    s_lshr_b32 s65, s2, 3
    s_and_b32 s70, s64, 1
    s_lshl_b32 s70, s70, 3
    s_and_b32 s66, s65, 7
    s_add_u32 s70, s70, s66
    s_lshr_b32 s71, s64, 1
    s_lshl_b32 s71, s71, 2
    s_lshr_b32 s66, s65, 3
    s_add_u32 s71, s71, s66
    v_mul_u32_u24 v8, 0x2493, v4
    v_lshrrev_b32 v8, 17, v8
    v_mul_u32_u24 v9, 14, v8
    v_sub_u32 v9, v4, v9
    v_mul_u32_u24 v8, 3584, v8
    v_lshl_add_u32 v8, v9, 4, v8
    s_mul_i32 s66, s71, 224
    v_add_u32 v10, s66, v8
    s_mul_i32 s72, s68, 28672
    s_mul_i32 s73, s68, 1920
    v_mul_u32_u24 v5, 1920, v2
    v_lshrrev_b32 v6, 2, v1
    v_mul_u32_u24 v6, 224, v6
    v_and_b32 v7, 3, v0
    v_lshl_add_u32 v6, v7, 3, v6
    v_add_u32 v11, v5, v6
    v_lshrrev_b32 v5, 3, v4
    v_and_b32 v6, 7, v4
    s_lshl_b32 s66, s70, 7
    s_lshl_b32 s67, s68, 5
    s_add_u32 s66, s66, s67
    v_add_u32 v7, s66, v5
    v_lshlrev_b32 v7, 10, v7
    v_xor_b32 v8, v6, v2
    v_lshl_add_u32 v12, v8, 4, v7
    v_xor_b32 v8, 4, v8
    v_lshl_add_u32 v13, v8, 4, v7
    s_lshl_b32 s74, s68, 12
    s_add_u32 s74, s74, 46080
    v_lshrrev_b32 v7, 1, v1
    v_xor_b32 v8, v2, v7
    v_lshlrev_b32 v9, 7, v1
    v_add_u32 v9, s74, v9
    v_lshl_add_u32 v14, v8, 4, v9
    v_xor_b32 v8, 4, v8
    v_lshl_add_u32 v15, v8, 4, v9
    s_waitcnt vmcnt(0)
    v_mov_b32 v122, 0
    s_cmp_lg_u32 s68, 0
    s_cbranch_scc1 TI_2
    buffer_load_dword v123, v122, s[48:51], 0 offen sc1
TI_2:
    s_mov_b32 s81, 0xffff0000
    v_mov_b32 v80, 0x3b000000
    v_lshlrev_b32 v130, 16, v16
    v_and_b32 v131, s81, v16
    v_lshlrev_b32 v132, 16, v17
    v_and_b32 v133, s81, v17
    v_lshlrev_b32 v134, 16, v18
    v_and_b32 v135, s81, v18
    v_lshlrev_b32 v136, 16, v19
    v_and_b32 v137, s81, v19
    v_add_f32 v64, v130, v131
    v_add_f32 v70, v132, v133
    v_add_f32 v71, v134, v135
    v_add_f32 v72, v136, v137
    v_add_f32 v64, v64, v70
    v_add_f32 v71, v71, v72
    v_add_f32 v64, v64, v71
    v_lshlrev_b32 v138, 16, v20
    v_and_b32 v139, s81, v20
    v_lshlrev_b32 v140, 16, v21
    v_and_b32 v141, s81, v21
    v_lshlrev_b32 v142, 16, v22
    v_and_b32 v143, s81, v22
    v_lshlrev_b32 v144, 16, v23
    v_and_b32 v145, s81, v23
    v_add_f32 v65, v138, v139
    v_add_f32 v70, v140, v141
    v_add_f32 v71, v142, v143
    v_add_f32 v72, v144, v145
    v_add_f32 v65, v65, v70
    v_add_f32 v71, v71, v72
    v_add_f32 v65, v65, v71
    v_add_f32_dpp v64, v64, v64 row_shr:1 row_mask:0xf bank_mask:0xf
    s_nop 0
    v_add_f32_dpp v65, v65, v65 row_shr:1 row_mask:0xf bank_mask:0xf
    v_add_f32_dpp v64, v64, v64 row_shr:2 row_mask:0xf bank_mask:0xf
    s_nop 0
    v_add_f32_dpp v65, v65, v65 row_shr:2 row_mask:0xf bank_mask:0xf
    v_add_f32_dpp v64, v64, v64 row_shr:4 row_mask:0xf bank_mask:0xf
    s_nop 0
    v_add_f32_dpp v65, v65, v65 row_shr:4 row_mask:0xf bank_mask:0xf
    v_add_f32_dpp v64, v64, v64 row_shr:8 row_mask:0xf bank_mask:0xf
    s_nop 0
    v_add_f32_dpp v65, v65, v65 row_shr:8 row_mask:0xf bank_mask:0xf
    v_add_f32_dpp v64, v64, v64 row_bcast:15 row_mask:0xa bank_mask:0xf
    s_nop 0
    v_add_f32_dpp v65, v65, v65 row_bcast:15 row_mask:0xa bank_mask:0xf
    v_add_f32_dpp v64, v64, v64 row_bcast:31 row_mask:0xc bank_mask:0xf
    s_nop 0
    v_add_f32_dpp v65, v65, v65 row_bcast:31 row_mask:0xc bank_mask:0xf
    v_readlane_b32 s64, v64, 63
    v_readlane_b32 s65, v65, 63
    s_nop 0
    v_mul_f32 v84, s64, v80
    v_mul_f32 v85, s65, v80
    v_sub_f32 v146, v130, v84
    v_sub_f32 v147, v131, v84
    v_sub_f32 v148, v132, v84
    v_sub_f32 v149, v133, v84
    v_sub_f32 v150, v134, v84
    v_sub_f32 v151, v135, v84
    v_sub_f32 v152, v136, v84
    v_sub_f32 v153, v137, v84
    v_sub_f32 v154, v138, v85
    v_sub_f32 v155, v139, v85
    v_sub_f32 v156, v140, v85
    v_sub_f32 v157, v141, v85
    v_sub_f32 v158, v142, v85
    v_sub_f32 v159, v143, v85
    v_sub_f32 v160, v144, v85
    v_sub_f32 v161, v145, v85
    v_mul_f32 v64, v146, v146
    v_mul_f32 v65, v154, v154
    v_fmac_f32 v64, v147, v147
    v_fmac_f32 v65, v155, v155
    v_fmac_f32 v64, v148, v148
    v_fmac_f32 v65, v156, v156
    v_fmac_f32 v64, v149, v149
    v_fmac_f32 v65, v157, v157
    v_fmac_f32 v64, v150, v150
    v_fmac_f32 v65, v158, v158
    v_fmac_f32 v64, v151, v151
    v_fmac_f32 v65, v159, v159
    v_fmac_f32 v64, v152, v152
    v_fmac_f32 v65, v160, v160
    v_fmac_f32 v64, v153, v153
    v_fmac_f32 v65, v161, v161
    s_nop 0
    v_add_f32_dpp v64, v64, v64 row_shr:1 row_mask:0xf bank_mask:0xf
    v_add_f32_dpp v65, v65, v65 row_shr:1 row_mask:0xf bank_mask:0xf
    s_nop 0
    v_add_f32_dpp v64, v64, v64 row_shr:2 row_mask:0xf bank_mask:0xf
    v_add_f32_dpp v65, v65, v65 row_shr:2 row_mask:0xf bank_mask:0xf
    s_nop 0
    v_add_f32_dpp v64, v64, v64 row_shr:4 row_mask:0xf bank_mask:0xf
    v_add_f32_dpp v65, v65, v65 row_shr:4 row_mask:0xf bank_mask:0xf
    s_nop 0
    v_add_f32_dpp v64, v64, v64 row_shr:8 row_mask:0xf bank_mask:0xf
    v_add_f32_dpp v65, v65, v65 row_shr:8 row_mask:0xf bank_mask:0xf
    s_nop 0
    v_add_f32_dpp v64, v64, v64 row_bcast:15 row_mask:0xa bank_mask:0xf
    v_add_f32_dpp v65, v65, v65 row_bcast:15 row_mask:0xa bank_mask:0xf
    s_nop 0
    v_add_f32_dpp v64, v64, v64 row_bcast:31 row_mask:0xc bank_mask:0xf
    v_add_f32_dpp v65, v65, v65 row_bcast:31 row_mask:0xc bank_mask:0xf
    v_readlane_b32 s64, v64, 63
    v_readlane_b32 s65, v65, 63
    s_mov_b32 s66, 0x3727c5ac
    v_mul_f32 v70, s64, v80
    v_mul_f32 v71, s65, v80
    v_cvt_pk_bf16_f32 v72, v84, v70
    v_cvt_pk_bf16_f32 v73, v85, v71
    v_lshlrev_b32 v84, 16, v72
    v_lshlrev_b32 v85, 16, v73
    v_and_b32 v70, s81, v72
    v_and_b32 v71, s81, v73
    v_add_f32 v70, s66, v70
    v_add_f32 v71, s66, v71
    v_cvt_pk_bf16_f32 v70, v70, v70
    v_cvt_pk_bf16_f32 v71, v71, v71
    v_and_b32 v70, s81, v70
    v_and_b32 v71, s81, v71
    v_sqrt_f32 v70, v70
    v_sqrt_f32 v71, v71
    v_cvt_pk_bf16_f32 v70, v70, v70
    v_cvt_pk_bf16_f32 v71, v71, v71
    v_and_b32 v88, s81, v70
    v_and_b32 v89, s81, v71
    v_rcp_f32 v92, v88
    v_rcp_f32 v93, v89
    v_sub_f32 v146, v130, v84
    v_sub_f32 v147, v131, v84
    v_sub_f32 v148, v132, v84
    v_sub_f32 v149, v133, v84
    v_sub_f32 v150, v134, v84
    v_sub_f32 v151, v135, v84
    v_sub_f32 v152, v136, v84
    v_sub_f32 v153, v137, v84
    v_cvt_pk_bf16_f32 v74, v146, v147
    v_cvt_pk_bf16_f32 v75, v148, v149
    v_cvt_pk_bf16_f32 v76, v150, v151
    v_cvt_pk_bf16_f32 v77, v152, v153
    v_lshlrev_b32 v146, 16, v74
    v_and_b32 v147, s81, v74
    v_lshlrev_b32 v148, 16, v75
    v_and_b32 v149, s81, v75
    v_lshlrev_b32 v150, 16, v76
    v_and_b32 v151, s81, v76
    v_lshlrev_b32 v152, 16, v77
    v_and_b32 v153, s81, v77
    v_mul_f32 v162, v146, v92
    v_mul_f32 v163, v147, v92
    v_mul_f32 v164, v148, v92
    v_mul_f32 v165, v149, v92
    v_mul_f32 v166, v150, v92
    v_mul_f32 v167, v151, v92
    v_mul_f32 v168, v152, v92
    v_mul_f32 v169, v153, v92
    v_fma_f32 v146, -v162, v88, v146
    v_fma_f32 v147, -v163, v88, v147
    v_fma_f32 v148, -v164, v88, v148
    v_fma_f32 v149, -v165, v88, v149
    v_fma_f32 v150, -v166, v88, v150
    v_fma_f32 v151, -v167, v88, v151
    v_fma_f32 v152, -v168, v88, v152
    v_fma_f32 v153, -v169, v88, v153
    v_fmac_f32 v162, v146, v92
    v_fmac_f32 v163, v147, v92
    v_fmac_f32 v164, v148, v92
    v_fmac_f32 v165, v149, v92
    v_fmac_f32 v166, v150, v92
    v_fmac_f32 v167, v151, v92
    v_fmac_f32 v168, v152, v92
    v_fmac_f32 v169, v153, v92
    v_cvt_pk_bf16_f32 v16, v162, v163
    v_cvt_pk_bf16_f32 v17, v164, v165
    v_cvt_pk_bf16_f32 v18, v166, v167
    v_cvt_pk_bf16_f32 v19, v168, v169
    buffer_store_dwordx4 v[16:19], v111, s[12:15], 0 offen offset:0 sc1
    ds_write_b128 v110, v[16:19] offset:0
    v_sub_f32 v154, v138, v85
    v_sub_f32 v155, v139, v85
    v_sub_f32 v156, v140, v85
    v_sub_f32 v157, v141, v85
    v_sub_f32 v158, v142, v85
    v_sub_f32 v159, v143, v85
    v_sub_f32 v160, v144, v85
    v_sub_f32 v161, v145, v85
    v_cvt_pk_bf16_f32 v74, v154, v155
    v_cvt_pk_bf16_f32 v75, v156, v157
    v_cvt_pk_bf16_f32 v76, v158, v159
    v_cvt_pk_bf16_f32 v77, v160, v161
    v_lshlrev_b32 v154, 16, v74
    v_and_b32 v155, s81, v74
    v_lshlrev_b32 v156, 16, v75
    v_and_b32 v157, s81, v75
    v_lshlrev_b32 v158, 16, v76
    v_and_b32 v159, s81, v76
    v_lshlrev_b32 v160, 16, v77
    v_and_b32 v161, s81, v77
    v_mul_f32 v170, v154, v93
    v_mul_f32 v171, v155, v93
    v_mul_f32 v172, v156, v93
    v_mul_f32 v173, v157, v93
    v_mul_f32 v174, v158, v93
    v_mul_f32 v175, v159, v93
    v_mul_f32 v176, v160, v93
    v_mul_f32 v177, v161, v93
    v_fma_f32 v154, -v170, v89, v154
    v_fma_f32 v155, -v171, v89, v155
    v_fma_f32 v156, -v172, v89, v156
    v_fma_f32 v157, -v173, v89, v157
    v_fma_f32 v158, -v174, v89, v158
    v_fma_f32 v159, -v175, v89, v159
    v_fma_f32 v160, -v176, v89, v160
    v_fma_f32 v161, -v177, v89, v161
    v_fmac_f32 v170, v154, v93
    v_fmac_f32 v171, v155, v93
    v_fmac_f32 v172, v156, v93
    v_fmac_f32 v173, v157, v93
    v_fmac_f32 v174, v158, v93
    v_fmac_f32 v175, v159, v93
    v_fmac_f32 v176, v160, v93
    v_fmac_f32 v177, v161, v93
    v_cvt_pk_bf16_f32 v20, v170, v171
    v_cvt_pk_bf16_f32 v21, v172, v173
    v_cvt_pk_bf16_f32 v22, v174, v175
    v_cvt_pk_bf16_f32 v23, v176, v177
    buffer_store_dwordx4 v[20:23], v111, s[12:15], 0 offen offset:1024 sc1
    ds_write_b128 v110, v[20:23] offset:1024
    s_waitcnt lgkmcnt(0)
    s_barrier
    v_lshlrev_b32 v7, 2, v0
    v_add_u32 v7, 62464, v7
    ds_read_b32 v180, v7 offset:0
    ds_read_b32 v181, v7 offset:1024
    ds_read_b32 v182, v7 offset:2048
    ds_read_b32 v183, v7 offset:3072
    ds_read_b32 v184, v7 offset:4096
    ds_read_b32 v185, v7 offset:5120
    ds_read_b32 v186, v7 offset:6144
    ds_read_b32 v187, v7 offset:7168
    s_mov_b32 s64, 0x05040100
    s_mov_b32 s65, 0x07060302
    v_mul_u32_u24 v8, 8320, v0
    s_lshl_b32 s3, s2, 4
    s_add_u32 s3, s3, 32
    v_add_u32 v8, s3, v8
    s_movk_i32 s66, 4160
    s_waitcnt lgkmcnt(0)
    v_perm_b32 v190, v181, v180, s64
    v_perm_b32 v194, v181, v180, s65
    v_perm_b32 v191, v183, v182, s64
    v_perm_b32 v195, v183, v182, s65
    v_perm_b32 v192, v185, v184, s64
    v_perm_b32 v196, v185, v184, s65
    v_perm_b32 v193, v187, v186, s64
    v_perm_b32 v197, v187, v186, s65
    buffer_store_dwordx4 v[190:193], v8, s[16:19], 0 offen sc1
    buffer_store_dwordx4 v[194:197], v8, s[16:19], s66 offen sc1
    s_mul_i32 s3, s2, 8320
    v_and_b32 v7, 1, v0
    v_lshlrev_b32 v7, 4, v7
    v_bfe_u32 v9, v0, 1, 1
    v_mul_u32_u24 v9, 4128, v9
    v_add_u32 v7, v7, v9
    v_bfe_u32 v9, v0, 2, 1
    v_mul_u32_u24 v9, 4160, v9
    v_add3_u32 v7, v7, v9, s3
    v_mov_b32 v198, 0
    v_mov_b32 v199, 0
    v_mov_b32 v200, 0
    v_mov_b32 v201, 0
    v_cmp_gt_u32 vcc, 8, v0
    s_nop 0
    s_and_saveexec_b64 s[64:65], vcc
    s_cbranch_execz MK_3
    buffer_store_dwordx4 v[198:201], v7, s[16:19], 0 offen sc1
MK_3:
    s_mov_b64 exec, s[64:65]
    s_cmp_lg_u32 s68, 0
    s_cbranch_scc1 TGE_5
    s_waitcnt vmcnt(4)
    s_mov_b32 s66, 0
TG_4:
    v_readfirstlane_b32 s83, v123
    s_add_u32 s66, s66, 1
    s_cmp_lg_u32 s83, 0
    s_cbranch_scc1 TGE_5
    s_cmp_gt_u32 s66, 0x40000
    s_cbranch_scc1 TGE_5
    s_sleep 8
    buffer_load_dword v123, v122, s[48:51], 0 offen sc1
    s_waitcnt vmcnt(0)
    s_branch TG_4
TGE_5:
    s_waitcnt vmcnt(2)
    s_barrier
    v_mov_b32 v5, s83
    s_lshl_b32 s64, s2, 2
    s_add_u32 s64, s64, 0
    v_lshlrev_b32 v6, 10, v0
    v_add_u32 v6, s64, v6
    v_cmp_gt_u32 vcc, 8, v0
    s_nop 0
    s_and_saveexec_b64 s[64:65], vcc
    s_cbranch_execz MK_6
    buffer_store_dword v5, v6, s[4:7], 0 offen sc1
MK_6:
    s_mov_b64 exec, s[64:65]
    s_add_u32 s66, s72, 0
    s_add_u32 m0, s73, 0
    s_mov_b32 exec_hi, 0x00ffffff
    buffer_load_dwordx4 v10, s[28:31], s66 offen lds
    s_mov_b32 exec_hi, -1
    s_add_u32 s66, s72, 14336
    s_add_u32 m0, s73, 960
    s_mov_b32 exec_hi, 0x00ffffff
    buffer_load_dwordx4 v10, s[28:31], s66 offen lds
    s_mov_b32 exec_hi, -1
    s_add_u32 s66, s72, 0
    s_add_u32 m0, s73, 7680
    s_mov_b32 exec_hi, 0x00ffffff
    buffer_load_dwordx4 v10, s[32:35], s66 offen lds
    s_mov_b32 exec_hi, -1
    s_add_u32 s66, s72, 14336
    s_add_u32 m0, s73, 8640
    s_mov_b32 exec_hi, 0x00ffffff
    buffer_load_dwordx4 v10, s[32:35], s66 offen lds
    s_mov_b32 exec_hi, -1
    s_add_u32 s66, s72, 114688
    s_add_u32 m0, s73, 15360
    s_mov_b32 exec_hi, 0x00ffffff
    buffer_load_dwordx4 v10, s[28:31], s66 offen lds
    s_mov_b32 exec_hi, -1
    s_add_u32 s66, s72, 129024
    s_add_u32 m0, s73, 16320
    s_mov_b32 exec_hi, 0x00ffffff
    buffer_load_dwordx4 v10, s[28:31], s66 offen lds
    s_mov_b32 exec_hi, -1
    s_add_u32 s66, s72, 114688
    s_add_u32 m0, s73, 23040
    s_mov_b32 exec_hi, 0x00ffffff
    buffer_load_dwordx4 v10, s[32:35], s66 offen lds
    s_mov_b32 exec_hi, -1
    s_add_u32 s66, s72, 129024
    s_add_u32 m0, s73, 24000
    s_mov_b32 exec_hi, 0x00ffffff
    buffer_load_dwordx4 v10, s[32:35], s66 offen lds
    s_mov_b32 exec_hi, -1
    s_add_u32 s66, s72, 229376
    s_add_u32 m0, s73, 30720
    s_mov_b32 exec_hi, 0x00ffffff
    buffer_load_dwordx4 v10, s[28:31], s66 offen lds
    s_mov_b32 exec_hi, -1
    s_add_u32 s66, s72, 243712
    s_add_u32 m0, s73, 31680
    s_mov_b32 exec_hi, 0x00ffffff
    buffer_load_dwordx4 v10, s[28:31], s66 offen lds
    s_mov_b32 exec_hi, -1
    s_add_u32 s66, s72, 229376
    s_add_u32 m0, s73, 38400
    s_mov_b32 exec_hi, 0x00ffffff
    buffer_load_dwordx4 v10, s[32:35], s66 offen lds
    s_mov_b32 exec_hi, -1
    s_add_u32 s66, s72, 243712
    s_add_u32 m0, s73, 39360
    s_mov_b32 exec_hi, 0x00ffffff
    buffer_load_dwordx4 v10, s[32:35], s66 offen lds
    s_mov_b32 exec_hi, -1
    s_waitcnt vmcnt(12)
    s_barrier
    v_mov_b32 v5, s83
    s_lshl_b32 s64, s2, 2
    s_add_u32 s64, s64, 24576
    v_lshlrev_b32 v6, 10, v0
    v_add_u32 v6, s64, v6
    v_cmp_gt_u32 vcc, 8, v0
    s_nop 0
    s_and_saveexec_b64 s[64:65], vcc
    s_cbranch_execz MK_7
    buffer_store_dword v5, v6, s[4:7], 0 offen sc1
MK_7:
    s_mov_b64 exec, s[64:65]
    s_and_b32 s64, s2, 7
    s_lshl_b32 s64, s64, 10
    s_lshl_b32 s65, s70, 6
    s_add_u32 s64, s64, s65
    v_and_b32 v16, 3, v4
    v_lshlrev_b32 v16, 4, v16
    v_add_u32 v16, s64, v16
    s_cmp_lg_u32 s68, 0
    s_cbranch_scc1 PI_8
    buffer_load_dwordx4 v[20:23], v16, s[4:7], 0 offen sc1
PI_8:
    s_cmp_lg_u32 s68, 0
    s_cbranch_scc1 POLLE_10
    s_waitcnt vmcnt(0)
    s_mov_b32 s66, 0
POLL_9:
    v_xor_b32 v20, s83, v20
    v_xor_b32 v21, s83, v21
    v_xor_b32 v22, s83, v22
    v_xor_b32 v23, s83, v23
    v_or3_b32 v20, v20, v21, v22
    v_or_b32 v20, v20, v23
    v_cmp_ne_u32 vcc, 0, v20
    s_add_u32 s66, s66, 1
    s_nop 1
    s_cmp_eq_u64 vcc, 0
    s_cbranch_scc1 POLLE_10
    s_cmp_gt_u32 s66, 0x40000
    s_cbranch_scc1 POLLE_10
    s_sleep 12
    buffer_load_dwordx4 v[20:23], v16, s[4:7], 0 offen sc1
    s_waitcnt vmcnt(0)
    s_branch POLL_9
POLLE_10:
    s_barrier
    s_mov_b32 s66, 0
    s_add_u32 m0, s74, 0
    s_nop 0
    buffer_load_dwordx4 v12, s[12:15], s66 offen sc1 lds
    s_mov_b32 s66, 8192
    s_add_u32 m0, s74, 1024
    s_nop 0
    buffer_load_dwordx4 v13, s[12:15], s66 offen sc1 lds
    s_mov_b32 s66, 16384
    s_add_u32 m0, s74, 2048
    s_nop 0
    buffer_load_dwordx4 v12, s[12:15], s66 offen sc1 lds
    s_mov_b32 s66, 24576
    s_add_u32 m0, s74, 3072
    s_nop 0
    buffer_load_dwordx4 v13, s[12:15], s66 offen sc1 lds
    s_mov_b32 s66, 128
    s_add_u32 m0, s74, 16384
    s_nop 0
    buffer_load_dwordx4 v12, s[12:15], s66 offen sc1 lds
    s_mov_b32 s66, 8320
    s_add_u32 m0, s74, 17408
    s_nop 0
    buffer_load_dwordx4 v13, s[12:15], s66 offen sc1 lds
    s_mov_b32 s66, 16512
    s_add_u32 m0, s74, 18432
    s_nop 0
    buffer_load_dwordx4 v12, s[12:15], s66 offen sc1 lds
    s_mov_b32 s66, 24704
    s_add_u32 m0, s74, 19456
    s_nop 0
    buffer_load_dwordx4 v13, s[12:15], s66 offen sc1 lds
    v_mov_b32 v128, 0
    v_mov_b32 v129, 0
    v_mov_b32 v130, 0
    v_mov_b32 v131, 0
    v_mov_b32 v132, 0
    v_mov_b32 v133, 0
    v_mov_b32 v134, 0
    v_mov_b32 v135, 0
    v_mov_b32 v136, 0
    v_mov_b32 v137, 0
    v_mov_b32 v138, 0
    v_mov_b32 v139, 0
    v_mov_b32 v140, 0
    v_mov_b32 v141, 0
    v_mov_b32 v142, 0
    v_mov_b32 v143, 0
    v_mov_b32 v144, 0
    v_mov_b32 v145, 0
    v_mov_b32 v146, 0
    v_mov_b32 v147, 0
    v_mov_b32 v148, 0
    v_mov_b32 v149, 0
    v_mov_b32 v150, 0
    v_mov_b32 v151, 0
    v_mov_b32 v152, 0
    v_mov_b32 v153, 0
    v_mov_b32 v154, 0
    v_mov_b32 v155, 0
    v_mov_b32 v156, 0
    v_mov_b32 v157, 0
    v_mov_b32 v158, 0
    v_mov_b32 v159, 0
    v_mov_b32 v160, 0
    v_mov_b32 v161, 0
    v_mov_b32 v162, 0
    v_mov_b32 v163, 0
    v_mov_b32 v164, 0
    v_mov_b32 v165, 0
    v_mov_b32 v166, 0
    v_mov_b32 v167, 0
    v_mov_b32 v168, 0
    v_mov_b32 v169, 0
    v_mov_b32 v170, 0
    v_mov_b32 v171, 0
    v_mov_b32 v172, 0
    v_mov_b32 v173, 0
    v_mov_b32 v174, 0
    v_mov_b32 v175, 0
    v_mov_b32 v176, 0
    v_mov_b32 v177, 0
    v_mov_b32 v178, 0
    v_mov_b32 v179, 0
    v_mov_b32 v180, 0
    v_mov_b32 v181, 0
    v_mov_b32 v182, 0
    v_mov_b32 v183, 0
    v_mov_b32 v184, 0
    v_mov_b32 v185, 0
    v_mov_b32 v186, 0
    v_mov_b32 v187, 0
    v_mov_b32 v188, 0
    v_mov_b32 v189, 0
    v_mov_b32 v190, 0
    v_mov_b32 v191, 0
    v_mov_b32 v192, 0
    v_mov_b32 v193, 0
    v_mov_b32 v194, 0
    v_mov_b32 v195, 0
    v_mov_b32 v196, 0
    v_mov_b32 v197, 0
    v_mov_b32 v198, 0
    v_mov_b32 v199, 0
    v_mov_b32 v200, 0
    v_mov_b32 v201, 0
    v_mov_b32 v202, 0
    v_mov_b32 v203, 0
    v_mov_b32 v204, 0
    v_mov_b32 v205, 0
    v_mov_b32 v206, 0
    v_mov_b32 v207, 0
    v_mov_b32 v208, 0
    v_mov_b32 v209, 0
    v_mov_b32 v210, 0
    v_mov_b32 v211, 0
    v_mov_b32 v212, 0
    v_mov_b32 v213, 0
    v_mov_b32 v214, 0
    v_mov_b32 v215, 0
    v_mov_b32 v216, 0
    v_mov_b32 v217, 0
    v_mov_b32 v218, 0
    v_mov_b32 v219, 0
    v_mov_b32 v220, 0
    v_mov_b32 v221, 0
    v_mov_b32 v222, 0
    v_mov_b32 v223, 0
    v_mov_b32 v224, 0
    v_mov_b32 v225, 0
    v_mov_b32 v226, 0
    v_mov_b32 v227, 0
    v_mov_b32 v228, 0
    v_mov_b32 v229, 0
    v_mov_b32 v230, 0
    v_mov_b32 v231, 0
    v_mov_b32 v232, 0
    v_mov_b32 v233, 0
    v_mov_b32 v234, 0
    v_mov_b32 v235, 0
    v_mov_b32 v236, 0
    v_mov_b32 v237, 0
    v_mov_b32 v238, 0
    v_mov_b32 v239, 0
    s_waitcnt vmcnt(4)
    s_barrier
    ds_read_b128 v[240:243], v14 offset:0
    ds_read_b128 v[244:247], v14 offset:2048
    ds_read_b64_tr_b16 v[16:17], v11 offset:0
    ds_read_b64_tr_b16 v[18:19], v11 offset:960
    ds_read_b64_tr_b16 v[44:45], v11 offset:7680
    ds_read_b64_tr_b16 v[46:47], v11 offset:8640
    ds_read_b64_tr_b16 v[20:21], v11 offset:32
    ds_read_b64_tr_b16 v[22:23], v11 offset:992
    ds_read_b64_tr_b16 v[48:49], v11 offset:7712
    ds_read_b64_tr_b16 v[50:51], v11 offset:8672
    ds_read_b64_tr_b16 v[24:25], v11 offset:64
    ds_read_b64_tr_b16 v[26:27], v11 offset:1024
    ds_read_b64_tr_b16 v[52:53], v11 offset:7744
    ds_read_b64_tr_b16 v[54:55], v11 offset:8704
    ds_read_b64_tr_b16 v[28:29], v11 offset:96
    ds_read_b64_tr_b16 v[30:31], v11 offset:1056
    ds_read_b64_tr_b16 v[56:57], v11 offset:7776
    ds_read_b64_tr_b16 v[58:59], v11 offset:8736
    ds_read_b64_tr_b16 v[32:33], v11 offset:128
    ds_read_b64_tr_b16 v[34:35], v11 offset:1088
    ds_read_b64_tr_b16 v[60:61], v11 offset:7808
    ds_read_b64_tr_b16 v[62:63], v11 offset:8768
    ds_read_b64_tr_b16 v[36:37], v11 offset:160
    ds_read_b64_tr_b16 v[38:39], v11 offset:1120
    ds_read_b64_tr_b16 v[64:65], v11 offset:7840
    ds_read_b64_tr_b16 v[66:67], v11 offset:8800
    ds_read_b64_tr_b16 v[40:41], v11 offset:192
    ds_read_b64_tr_b16 v[42:43], v11 offset:1152
    ds_read_b64_tr_b16 v[68:69], v11 offset:7872
    ds_read_b64_tr_b16 v[70:71], v11 offset:8832
    s_waitcnt lgkmcnt(0)
    s_barrier
    v_mfma_f32_16x16x32_bf16 v[128:131], v[16:19], v[240:243], v[128:131]
    ds_read_b128 v[248:251], v15 offset:0
    ds_read_b128 v[252:255], v15 offset:2048
    v_mfma_f32_16x16x32_bf16 v[184:187], v[16:19], v[244:247], v[184:187]
    ds_read_b64_tr_b16 v[72:73], v11 offset:15360
    ds_read_b64_tr_b16 v[74:75], v11 offset:16320
    s_add_u32 s66, s72, 344064
    s_add_u32 m0, s73, 0
    s_mov_b32 exec_hi, 0x00ffffff
    buffer_load_dwordx4 v10, s[28:31], s66 offen lds
    s_mov_b32 exec_hi, -1
    v_mfma_f32_16x16x32_bf16 v[156:159], v[44:47], v[240:243], v[156:159]
    ds_read_b64_tr_b16 v[100:101], v11 offset:23040
    ds_read_b64_tr_b16 v[102:103], v11 offset:24000
    v_mfma_f32_16x16x32_bf16 v[212:215], v[44:47], v[244:247], v[212:215]
    ds_read_b64_tr_b16 v[76:77], v11 offset:15392
    ds_read_b64_tr_b16 v[78:79], v11 offset:16352
    v_mfma_f32_16x16x32_bf16 v[132:135], v[20:23], v[240:243], v[132:135]
    ds_read_b64_tr_b16 v[104:105], v11 offset:23072
    s_add_u32 s66, s72, 358400
    s_add_u32 m0, s73, 960
    s_mov_b32 exec_hi, 0x00ffffff
    buffer_load_dwordx4 v10, s[28:31], s66 offen lds
    s_mov_b32 exec_hi, -1
    v_mfma_f32_16x16x32_bf16 v[188:191], v[20:23], v[244:247], v[188:191]
    ds_read_b64_tr_b16 v[106:107], v11 offset:24032
    v_mfma_f32_16x16x32_bf16 v[160:163], v[48:51], v[240:243], v[160:163]
    ds_read_b64_tr_b16 v[80:81], v11 offset:15424
    v_mfma_f32_16x16x32_bf16 v[216:219], v[48:51], v[244:247], v[216:219]
    ds_read_b64_tr_b16 v[82:83], v11 offset:16384
    s_add_u32 s66, s72, 344064
    s_add_u32 m0, s73, 7680
    s_mov_b32 exec_hi, 0x00ffffff
    buffer_load_dwordx4 v10, s[32:35], s66 offen lds
    s_mov_b32 exec_hi, -1
    v_mfma_f32_16x16x32_bf16 v[136:139], v[24:27], v[240:243], v[136:139]
    ds_read_b64_tr_b16 v[108:109], v11 offset:23104
    v_mfma_f32_16x16x32_bf16 v[192:195], v[24:27], v[244:247], v[192:195]
    ds_read_b64_tr_b16 v[110:111], v11 offset:24064
    v_mfma_f32_16x16x32_bf16 v[164:167], v[52:55], v[240:243], v[164:167]
    ds_read_b64_tr_b16 v[84:85], v11 offset:15456
    s_add_u32 s66, s72, 358400
    s_add_u32 m0, s73, 8640
    s_mov_b32 exec_hi, 0x00ffffff
    buffer_load_dwordx4 v10, s[32:35], s66 offen lds
    s_mov_b32 exec_hi, -1
    v_mfma_f32_16x16x32_bf16 v[220:223], v[52:55], v[244:247], v[220:223]
    ds_read_b64_tr_b16 v[86:87], v11 offset:16416
    v_mfma_f32_16x16x32_bf16 v[140:143], v[28:31], v[240:243], v[140:143]
    ds_read_b64_tr_b16 v[112:113], v11 offset:23136
    v_mfma_f32_16x16x32_bf16 v[196:199], v[28:31], v[244:247], v[196:199]
    ds_read_b64_tr_b16 v[114:115], v11 offset:24096
    v_mfma_f32_16x16x32_bf16 v[168:171], v[56:59], v[240:243], v[168:171]
    ds_read_b64_tr_b16 v[88:89], v11 offset:15488
    v_mfma_f32_16x16x32_bf16 v[224:227], v[56:59], v[244:247], v[224:227]
    ds_read_b64_tr_b16 v[90:91], v11 offset:16448
    v_mfma_f32_16x16x32_bf16 v[144:147], v[32:35], v[240:243], v[144:147]
    ds_read_b64_tr_b16 v[116:117], v11 offset:23168
    v_mfma_f32_16x16x32_bf16 v[200:203], v[32:35], v[244:247], v[200:203]
    ds_read_b64_tr_b16 v[118:119], v11 offset:24128
    v_mfma_f32_16x16x32_bf16 v[172:175], v[60:63], v[240:243], v[172:175]
    ds_read_b64_tr_b16 v[92:93], v11 offset:15520
    v_mfma_f32_16x16x32_bf16 v[228:231], v[60:63], v[244:247], v[228:231]
    ds_read_b64_tr_b16 v[94:95], v11 offset:16480
    v_mfma_f32_16x16x32_bf16 v[148:151], v[36:39], v[240:243], v[148:151]
    ds_read_b64_tr_b16 v[120:121], v11 offset:23200
    v_mfma_f32_16x16x32_bf16 v[204:207], v[36:39], v[244:247], v[204:207]
    ds_read_b64_tr_b16 v[122:123], v11 offset:24160
    v_mfma_f32_16x16x32_bf16 v[176:179], v[64:67], v[240:243], v[176:179]
    ds_read_b64_tr_b16 v[96:97], v11 offset:15552
    v_mfma_f32_16x16x32_bf16 v[232:235], v[64:67], v[244:247], v[232:235]
    ds_read_b64_tr_b16 v[98:99], v11 offset:16512
    v_mfma_f32_16x16x32_bf16 v[152:155], v[40:43], v[240:243], v[152:155]
    ds_read_b64_tr_b16 v[124:125], v11 offset:23232
    v_mfma_f32_16x16x32_bf16 v[208:211], v[40:43], v[244:247], v[208:211]
    ds_read_b64_tr_b16 v[126:127], v11 offset:24192
    v_mfma_f32_16x16x32_bf16 v[180:183], v[68:71], v[240:243], v[180:183]
    v_mfma_f32_16x16x32_bf16 v[236:239], v[68:71], v[244:247], v[236:239]
    s_waitcnt vmcnt(4)
    s_waitcnt lgkmcnt(0)
    s_barrier
    v_mfma_f32_16x16x32_bf16 v[128:131], v[72:75], v[248:251], v[128:131]
    ds_read_b128 v[240:243], v14 offset:16384
    ds_read_b128 v[244:247], v14 offset:18432
    v_mfma_f32_16x16x32_bf16 v[184:187], v[72:75], v[252:255], v[184:187]
    ds_read_b64_tr_b16 v[16:17], v11 offset:30720
    ds_read_b64_tr_b16 v[18:19], v11 offset:31680
    s_mov_b32 s66, 256
    s_add_u32 m0, s74, 0
    s_nop 0
    buffer_load_dwordx4 v12, s[12:15], s66 offen sc1 lds
    v_mfma_f32_16x16x32_bf16 v[156:159], v[100:103], v[248:251], v[156:159]
    ds_read_b64_tr_b16 v[44:45], v11 offset:38400
    ds_read_b64_tr_b16 v[46:47], v11 offset:39360
    v_mfma_f32_16x16x32_bf16 v[212:215], v[100:103], v[252:255], v[212:215]
    ds_read_b64_tr_b16 v[20:21], v11 offset:30752
    ds_read_b64_tr_b16 v[22:23], v11 offset:31712
    v_mfma_f32_16x16x32_bf16 v[132:135], v[76:79], v[248:251], v[132:135]
    ds_read_b64_tr_b16 v[48:49], v11 offset:38432
    s_mov_b32 s66, 8448
    s_add_u32 m0, s74, 1024
    s_nop 0
    buffer_load_dwordx4 v13, s[12:15], s66 offen sc1 lds
    v_mfma_f32_16x16x32_bf16 v[188:191], v[76:79], v[252:255], v[188:191]
    ds_read_b64_tr_b16 v[50:51], v11 offset:39392
    v_mfma_f32_16x16x32_bf16 v[160:163], v[104:107], v[248:251], v[160:163]
    ds_read_b64_tr_b16 v[24:25], v11 offset:30784
    v_mfma_f32_16x16x32_bf16 v[216:219], v[104:107], v[252:255], v[216:219]
    ds_read_b64_tr_b16 v[26:27], v11 offset:31744
    s_mov_b32 s66, 16640
    s_add_u32 m0, s74, 2048
    s_nop 0
    buffer_load_dwordx4 v12, s[12:15], s66 offen sc1 lds
    v_mfma_f32_16x16x32_bf16 v[136:139], v[80:83], v[248:251], v[136:139]
    ds_read_b64_tr_b16 v[52:53], v11 offset:38464
    v_mfma_f32_16x16x32_bf16 v[192:195], v[80:83], v[252:255], v[192:195]
    ds_read_b64_tr_b16 v[54:55], v11 offset:39424
    v_mfma_f32_16x16x32_bf16 v[164:167], v[108:111], v[248:251], v[164:167]
    ds_read_b64_tr_b16 v[28:29], v11 offset:30816
    s_mov_b32 s66, 24832
    s_add_u32 m0, s74, 3072
    s_nop 0
    buffer_load_dwordx4 v13, s[12:15], s66 offen sc1 lds
    v_mfma_f32_16x16x32_bf16 v[220:223], v[108:111], v[252:255], v[220:223]
    ds_read_b64_tr_b16 v[30:31], v11 offset:31776
    v_mfma_f32_16x16x32_bf16 v[140:143], v[84:87], v[248:251], v[140:143]
    ds_read_b64_tr_b16 v[56:57], v11 offset:38496
    v_mfma_f32_16x16x32_bf16 v[196:199], v[84:87], v[252:255], v[196:199]
    ds_read_b64_tr_b16 v[58:59], v11 offset:39456
    s_add_u32 s66, s72, 458752
    s_add_u32 m0, s73, 15360
    s_mov_b32 exec_hi, 0x00ffffff
    buffer_load_dwordx4 v10, s[28:31], s66 offen lds
    s_mov_b32 exec_hi, -1
    v_mfma_f32_16x16x32_bf16 v[168:171], v[112:115], v[248:251], v[168:171]
    ds_read_b64_tr_b16 v[32:33], v11 offset:30848
    v_mfma_f32_16x16x32_bf16 v[224:227], v[112:115], v[252:255], v[224:227]
    ds_read_b64_tr_b16 v[34:35], v11 offset:31808
    v_mfma_f32_16x16x32_bf16 v[144:147], v[88:91], v[248:251], v[144:147]
    ds_read_b64_tr_b16 v[60:61], v11 offset:38528
    s_add_u32 s66, s72, 473088
    s_add_u32 m0, s73, 16320
    s_mov_b32 exec_hi, 0x00ffffff
    buffer_load_dwordx4 v10, s[28:31], s66 offen lds
    s_mov_b32 exec_hi, -1
    v_mfma_f32_16x16x32_bf16 v[200:203], v[88:91], v[252:255], v[200:203]
    ds_read_b64_tr_b16 v[62:63], v11 offset:39488
    v_mfma_f32_16x16x32_bf16 v[172:175], v[116:119], v[248:251], v[172:175]
    ds_read_b64_tr_b16 v[36:37], v11 offset:30880
    v_mfma_f32_16x16x32_bf16 v[228:231], v[116:119], v[252:255], v[228:231]
    ds_read_b64_tr_b16 v[38:39], v11 offset:31840
    s_add_u32 s66, s72, 458752
    s_add_u32 m0, s73, 23040
    s_mov_b32 exec_hi, 0x00ffffff
    buffer_load_dwordx4 v10, s[32:35], s66 offen lds
    s_mov_b32 exec_hi, -1
    v_mfma_f32_16x16x32_bf16 v[148:151], v[92:95], v[248:251], v[148:151]
    ds_read_b64_tr_b16 v[64:65], v11 offset:38560
    v_mfma_f32_16x16x32_bf16 v[204:207], v[92:95], v[252:255], v[204:207]
    ds_read_b64_tr_b16 v[66:67], v11 offset:39520
    v_mfma_f32_16x16x32_bf16 v[176:179], v[120:123], v[248:251], v[176:179]
    ds_read_b64_tr_b16 v[40:41], v11 offset:30912
    s_add_u32 s66, s72, 473088
    s_add_u32 m0, s73, 24000
    s_mov_b32 exec_hi, 0x00ffffff
    buffer_load_dwordx4 v10, s[32:35], s66 offen lds
    s_mov_b32 exec_hi, -1
    v_mfma_f32_16x16x32_bf16 v[232:235], v[120:123], v[252:255], v[232:235]
    ds_read_b64_tr_b16 v[42:43], v11 offset:31872
    v_mfma_f32_16x16x32_bf16 v[152:155], v[96:99], v[248:251], v[152:155]
    ds_read_b64_tr_b16 v[68:69], v11 offset:38592
    v_mfma_f32_16x16x32_bf16 v[208:211], v[96:99], v[252:255], v[208:211]
    ds_read_b64_tr_b16 v[70:71], v11 offset:39552
    v_mfma_f32_16x16x32_bf16 v[180:183], v[124:127], v[248:251], v[180:183]
    v_mfma_f32_16x16x32_bf16 v[236:239], v[124:127], v[252:255], v[236:239]
    s_waitcnt vmcnt(8)
    s_waitcnt lgkmcnt(0)
    s_barrier
    v_mfma_f32_16x16x32_bf16 v[128:131], v[16:19], v[240:243], v[128:131]
    ds_read_b128 v[248:251], v15 offset:16384
    ds_read_b128 v[252:255], v15 offset:18432
    v_mfma_f32_16x16x32_bf16 v[184:187], v[16:19], v[244:247], v[184:187]
    ds_read_b64_tr_b16 v[72:73], v11 offset:0
    ds_read_b64_tr_b16 v[74:75], v11 offset:960
    s_add_u32 s66, s72, 573440
    s_add_u32 m0, s73, 30720
    s_mov_b32 exec_hi, 0x00ffffff
    buffer_load_dwordx4 v10, s[28:31], s66 offen lds
    s_mov_b32 exec_hi, -1
    v_mfma_f32_16x16x32_bf16 v[156:159], v[44:47], v[240:243], v[156:159]
    ds_read_b64_tr_b16 v[100:101], v11 offset:7680
    ds_read_b64_tr_b16 v[102:103], v11 offset:8640
    v_mfma_f32_16x16x32_bf16 v[212:215], v[44:47], v[244:247], v[212:215]
    ds_read_b64_tr_b16 v[76:77], v11 offset:32
    ds_read_b64_tr_b16 v[78:79], v11 offset:992
    v_mfma_f32_16x16x32_bf16 v[132:135], v[20:23], v[240:243], v[132:135]
    ds_read_b64_tr_b16 v[104:105], v11 offset:7712
    s_add_u32 s66, s72, 587776
    s_add_u32 m0, s73, 31680
    s_mov_b32 exec_hi, 0x00ffffff
    buffer_load_dwordx4 v10, s[28:31], s66 offen lds
    s_mov_b32 exec_hi, -1
    v_mfma_f32_16x16x32_bf16 v[188:191], v[20:23], v[244:247], v[188:191]
    ds_read_b64_tr_b16 v[106:107], v11 offset:8672
    v_mfma_f32_16x16x32_bf16 v[160:163], v[48:51], v[240:243], v[160:163]
    ds_read_b64_tr_b16 v[80:81], v11 offset:64
    v_mfma_f32_16x16x32_bf16 v[216:219], v[48:51], v[244:247], v[216:219]
    ds_read_b64_tr_b16 v[82:83], v11 offset:1024
    s_add_u32 s66, s72, 573440
    s_add_u32 m0, s73, 38400
    s_mov_b32 exec_hi, 0x00ffffff
    buffer_load_dwordx4 v10, s[32:35], s66 offen lds
    s_mov_b32 exec_hi, -1
    v_mfma_f32_16x16x32_bf16 v[136:139], v[24:27], v[240:243], v[136:139]
    ds_read_b64_tr_b16 v[108:109], v11 offset:7744
    v_mfma_f32_16x16x32_bf16 v[192:195], v[24:27], v[244:247], v[192:195]
    ds_read_b64_tr_b16 v[110:111], v11 offset:8704
    v_mfma_f32_16x16x32_bf16 v[164:167], v[52:55], v[240:243], v[164:167]
    ds_read_b64_tr_b16 v[84:85], v11 offset:96
    s_add_u32 s66, s72, 587776
    s_add_u32 m0, s73, 39360
    s_mov_b32 exec_hi, 0x00ffffff
    buffer_load_dwordx4 v10, s[32:35], s66 offen lds
    s_mov_b32 exec_hi, -1
    v_mfma_f32_16x16x32_bf16 v[220:223], v[52:55], v[244:247], v[220:223]
    ds_read_b64_tr_b16 v[86:87], v11 offset:1056
    v_mfma_f32_16x16x32_bf16 v[140:143], v[28:31], v[240:243], v[140:143]
    ds_read_b64_tr_b16 v[112:113], v11 offset:7776
    v_mfma_f32_16x16x32_bf16 v[196:199], v[28:31], v[244:247], v[196:199]
    ds_read_b64_tr_b16 v[114:115], v11 offset:8736
    v_mfma_f32_16x16x32_bf16 v[168:171], v[56:59], v[240:243], v[168:171]
    ds_read_b64_tr_b16 v[88:89], v11 offset:128
    v_mfma_f32_16x16x32_bf16 v[224:227], v[56:59], v[244:247], v[224:227]
    ds_read_b64_tr_b16 v[90:91], v11 offset:1088
    v_mfma_f32_16x16x32_bf16 v[144:147], v[32:35], v[240:243], v[144:147]
    ds_read_b64_tr_b16 v[116:117], v11 offset:7808
    v_mfma_f32_16x16x32_bf16 v[200:203], v[32:35], v[244:247], v[200:203]
    ds_read_b64_tr_b16 v[118:119], v11 offset:8768
    v_mfma_f32_16x16x32_bf16 v[172:175], v[60:63], v[240:243], v[172:175]
    ds_read_b64_tr_b16 v[92:93], v11 offset:160
    v_mfma_f32_16x16x32_bf16 v[228:231], v[60:63], v[244:247], v[228:231]
    ds_read_b64_tr_b16 v[94:95], v11 offset:1120
    v_mfma_f32_16x16x32_bf16 v[148:151], v[36:39], v[240:243], v[148:151]
    ds_read_b64_tr_b16 v[120:121], v11 offset:7840
    v_mfma_f32_16x16x32_bf16 v[204:207], v[36:39], v[244:247], v[204:207]
    ds_read_b64_tr_b16 v[122:123], v11 offset:8800
    v_mfma_f32_16x16x32_bf16 v[176:179], v[64:67], v[240:243], v[176:179]
    ds_read_b64_tr_b16 v[96:97], v11 offset:192
    v_mfma_f32_16x16x32_bf16 v[232:235], v[64:67], v[244:247], v[232:235]
    ds_read_b64_tr_b16 v[98:99], v11 offset:1152
    v_mfma_f32_16x16x32_bf16 v[152:155], v[40:43], v[240:243], v[152:155]
    ds_read_b64_tr_b16 v[124:125], v11 offset:7872
    v_mfma_f32_16x16x32_bf16 v[208:211], v[40:43], v[244:247], v[208:211]
    ds_read_b64_tr_b16 v[126:127], v11 offset:8832
    v_mfma_f32_16x16x32_bf16 v[180:183], v[68:71], v[240:243], v[180:183]
    v_mfma_f32_16x16x32_bf16 v[236:239], v[68:71], v[244:247], v[236:239]
    s_waitcnt vmcnt(4)
    s_waitcnt lgkmcnt(0)
    s_barrier
    v_mfma_f32_16x16x32_bf16 v[128:131], v[72:75], v[248:251], v[128:131]
    ds_read_b128 v[240:243], v14 offset:0
    ds_read_b128 v[244:247], v14 offset:2048
    v_mfma_f32_16x16x32_bf16 v[184:187], v[72:75], v[252:255], v[184:187]
    ds_read_b64_tr_b16 v[16:17], v11 offset:15360
    ds_read_b64_tr_b16 v[18:19], v11 offset:16320
    s_mov_b32 s66, 384
    s_add_u32 m0, s74, 16384
    s_nop 0
    buffer_load_dwordx4 v12, s[12:15], s66 offen sc1 lds
    v_mfma_f32_16x16x32_bf16 v[156:159], v[100:103], v[248:251], v[156:159]
    ds_read_b64_tr_b16 v[44:45], v11 offset:23040
    ds_read_b64_tr_b16 v[46:47], v11 offset:24000
    v_mfma_f32_16x16x32_bf16 v[212:215], v[100:103], v[252:255], v[212:215]
    ds_read_b64_tr_b16 v[20:21], v11 offset:15392
    ds_read_b64_tr_b16 v[22:23], v11 offset:16352
    v_mfma_f32_16x16x32_bf16 v[132:135], v[76:79], v[248:251], v[132:135]
    ds_read_b64_tr_b16 v[48:49], v11 offset:23072
    s_mov_b32 s66, 8576
    s_add_u32 m0, s74, 17408
    s_nop 0
    buffer_load_dwordx4 v13, s[12:15], s66 offen sc1 lds
    v_mfma_f32_16x16x32_bf16 v[188:191], v[76:79], v[252:255], v[188:191]
    ds_read_b64_tr_b16 v[50:51], v11 offset:24032
    v_mfma_f32_16x16x32_bf16 v[160:163], v[104:107], v[248:251], v[160:163]
    ds_read_b64_tr_b16 v[24:25], v11 offset:15424
    v_mfma_f32_16x16x32_bf16 v[216:219], v[104:107], v[252:255], v[216:219]
    ds_read_b64_tr_b16 v[26:27], v11 offset:16384
    s_mov_b32 s66, 16768
    s_add_u32 m0, s74, 18432
    s_nop 0
    buffer_load_dwordx4 v12, s[12:15], s66 offen sc1 lds
    v_mfma_f32_16x16x32_bf16 v[136:139], v[80:83], v[248:251], v[136:139]
    ds_read_b64_tr_b16 v[52:53], v11 offset:23104
    v_mfma_f32_16x16x32_bf16 v[192:195], v[80:83], v[252:255], v[192:195]
    ds_read_b64_tr_b16 v[54:55], v11 offset:24064
    v_mfma_f32_16x16x32_bf16 v[164:167], v[108:111], v[248:251], v[164:167]
    ds_read_b64_tr_b16 v[28:29], v11 offset:15456
    s_mov_b32 s66, 24960
    s_add_u32 m0, s74, 19456
    s_nop 0
    buffer_load_dwordx4 v13, s[12:15], s66 offen sc1 lds
    v_mfma_f32_16x16x32_bf16 v[220:223], v[108:111], v[252:255], v[220:223]
    ds_read_b64_tr_b16 v[30:31], v11 offset:16416
    v_mfma_f32_16x16x32_bf16 v[140:143], v[84:87], v[248:251], v[140:143]
    ds_read_b64_tr_b16 v[56:57], v11 offset:23136
    v_mfma_f32_16x16x32_bf16 v[196:199], v[84:87], v[252:255], v[196:199]
    ds_read_b64_tr_b16 v[58:59], v11 offset:24096
    s_add_u32 s66, s72, 688128
    s_add_u32 m0, s73, 0
    s_mov_b32 exec_hi, 0x00ffffff
    buffer_load_dwordx4 v10, s[28:31], s66 offen lds
    s_mov_b32 exec_hi, -1
    v_mfma_f32_16x16x32_bf16 v[168:171], v[112:115], v[248:251], v[168:171]
    ds_read_b64_tr_b16 v[32:33], v11 offset:15488
    v_mfma_f32_16x16x32_bf16 v[224:227], v[112:115], v[252:255], v[224:227]
    ds_read_b64_tr_b16 v[34:35], v11 offset:16448
    v_mfma_f32_16x16x32_bf16 v[144:147], v[88:91], v[248:251], v[144:147]
    ds_read_b64_tr_b16 v[60:61], v11 offset:23168
    s_add_u32 s66, s72, 702464
    s_add_u32 m0, s73, 960
    s_mov_b32 exec_hi, 0x00ffffff
    buffer_load_dwordx4 v10, s[28:31], s66 offen lds
    s_mov_b32 exec_hi, -1
    v_mfma_f32_16x16x32_bf16 v[200:203], v[88:91], v[252:255], v[200:203]
    ds_read_b64_tr_b16 v[62:63], v11 offset:24128
    v_mfma_f32_16x16x32_bf16 v[172:175], v[116:119], v[248:251], v[172:175]
    ds_read_b64_tr_b16 v[36:37], v11 offset:15520
    v_mfma_f32_16x16x32_bf16 v[228:231], v[116:119], v[252:255], v[228:231]
    ds_read_b64_tr_b16 v[38:39], v11 offset:16480
    s_add_u32 s66, s72, 688128
    s_add_u32 m0, s73, 7680
    s_mov_b32 exec_hi, 0x00ffffff
    buffer_load_dwordx4 v10, s[32:35], s66 offen lds
    s_mov_b32 exec_hi, -1
    v_mfma_f32_16x16x32_bf16 v[148:151], v[92:95], v[248:251], v[148:151]
    ds_read_b64_tr_b16 v[64:65], v11 offset:23200
    v_mfma_f32_16x16x32_bf16 v[204:207], v[92:95], v[252:255], v[204:207]
    ds_read_b64_tr_b16 v[66:67], v11 offset:24160
    v_mfma_f32_16x16x32_bf16 v[176:179], v[120:123], v[248:251], v[176:179]
    ds_read_b64_tr_b16 v[40:41], v11 offset:15552
    s_add_u32 s66, s72, 702464
    s_add_u32 m0, s73, 8640
    s_mov_b32 exec_hi, 0x00ffffff
    buffer_load_dwordx4 v10, s[32:35], s66 offen lds
    s_mov_b32 exec_hi, -1
    v_mfma_f32_16x16x32_bf16 v[232:235], v[120:123], v[252:255], v[232:235]
    ds_read_b64_tr_b16 v[42:43], v11 offset:16512
    v_mfma_f32_16x16x32_bf16 v[152:155], v[96:99], v[248:251], v[152:155]
    ds_read_b64_tr_b16 v[68:69], v11 offset:23232
    v_mfma_f32_16x16x32_bf16 v[208:211], v[96:99], v[252:255], v[208:211]
    ds_read_b64_tr_b16 v[70:71], v11 offset:24192
    v_mfma_f32_16x16x32_bf16 v[180:183], v[124:127], v[248:251], v[180:183]
    v_mfma_f32_16x16x32_bf16 v[236:239], v[124:127], v[252:255], v[236:239]
    s_waitcnt vmcnt(8)
    s_waitcnt lgkmcnt(0)
    s_barrier
    v_mfma_f32_16x16x32_bf16 v[128:131], v[16:19], v[240:243], v[128:131]
    ds_read_b128 v[248:251], v15 offset:0
    ds_read_b128 v[252:255], v15 offset:2048
    v_mfma_f32_16x16x32_bf16 v[184:187], v[16:19], v[244:247], v[184:187]
    ds_read_b64_tr_b16 v[72:73], v11 offset:30720
    ds_read_b64_tr_b16 v[74:75], v11 offset:31680
    s_add_u32 s66, s72, 802816
    s_add_u32 m0, s73, 15360
    s_mov_b32 exec_hi, 0x00ffffff
    buffer_load_dwordx4 v10, s[28:31], s66 offen lds
    s_mov_b32 exec_hi, -1
    v_mfma_f32_16x16x32_bf16 v[156:159], v[44:47], v[240:243], v[156:159]
    ds_read_b64_tr_b16 v[100:101], v11 offset:38400
    ds_read_b64_tr_b16 v[102:103], v11 offset:39360
    v_mfma_f32_16x16x32_bf16 v[212:215], v[44:47], v[244:247], v[212:215]
    ds_read_b64_tr_b16 v[76:77], v11 offset:30752
    ds_read_b64_tr_b16 v[78:79], v11 offset:31712
    v_mfma_f32_16x16x32_bf16 v[132:135], v[20:23], v[240:243], v[132:135]
    ds_read_b64_tr_b16 v[104:105], v11 offset:38432
    s_add_u32 s66, s72, 817152
    s_add_u32 m0, s73, 16320
    s_mov_b32 exec_hi, 0x00ffffff
    buffer_load_dwordx4 v10, s[28:31], s66 offen lds
    s_mov_b32 exec_hi, -1
    v_mfma_f32_16x16x32_bf16 v[188:191], v[20:23], v[244:247], v[188:191]
    ds_read_b64_tr_b16 v[106:107], v11 offset:39392
    v_mfma_f32_16x16x32_bf16 v[160:163], v[48:51], v[240:243], v[160:163]
    ds_read_b64_tr_b16 v[80:81], v11 offset:30784
    v_mfma_f32_16x16x32_bf16 v[216:219], v[48:51], v[244:247], v[216:219]
    ds_read_b64_tr_b16 v[82:83], v11 offset:31744
    s_add_u32 s66, s72, 802816
    s_add_u32 m0, s73, 23040
    s_mov_b32 exec_hi, 0x00ffffff
    buffer_load_dwordx4 v10, s[32:35], s66 offen lds
    s_mov_b32 exec_hi, -1
    v_mfma_f32_16x16x32_bf16 v[136:139], v[24:27], v[240:243], v[136:139]
    ds_read_b64_tr_b16 v[108:109], v11 offset:38464
    v_mfma_f32_16x16x32_bf16 v[192:195], v[24:27], v[244:247], v[192:195]
    ds_read_b64_tr_b16 v[110:111], v11 offset:39424
    v_mfma_f32_16x16x32_bf16 v[164:167], v[52:55], v[240:243], v[164:167]
    ds_read_b64_tr_b16 v[84:85], v11 offset:30816
    s_add_u32 s66, s72, 817152
    s_add_u32 m0, s73, 24000
    s_mov_b32 exec_hi, 0x00ffffff
    buffer_load_dwordx4 v10, s[32:35], s66 offen lds
    s_mov_b32 exec_hi, -1
    v_mfma_f32_16x16x32_bf16 v[220:223], v[52:55], v[244:247], v[220:223]
    ds_read_b64_tr_b16 v[86:87], v11 offset:31776
    v_mfma_f32_16x16x32_bf16 v[140:143], v[28:31], v[240:243], v[140:143]
    ds_read_b64_tr_b16 v[112:113], v11 offset:38496
    v_mfma_f32_16x16x32_bf16 v[196:199], v[28:31], v[244:247], v[196:199]
    ds_read_b64_tr_b16 v[114:115], v11 offset:39456
    v_mfma_f32_16x16x32_bf16 v[168:171], v[56:59], v[240:243], v[168:171]
    ds_read_b64_tr_b16 v[88:89], v11 offset:30848
    v_mfma_f32_16x16x32_bf16 v[224:227], v[56:59], v[244:247], v[224:227]
    ds_read_b64_tr_b16 v[90:91], v11 offset:31808
    v_mfma_f32_16x16x32_bf16 v[144:147], v[32:35], v[240:243], v[144:147]
    ds_read_b64_tr_b16 v[116:117], v11 offset:38528
    v_mfma_f32_16x16x32_bf16 v[200:203], v[32:35], v[244:247], v[200:203]
    ds_read_b64_tr_b16 v[118:119], v11 offset:39488
    v_mfma_f32_16x16x32_bf16 v[172:175], v[60:63], v[240:243], v[172:175]
    ds_read_b64_tr_b16 v[92:93], v11 offset:30880
    v_mfma_f32_16x16x32_bf16 v[228:231], v[60:63], v[244:247], v[228:231]
    ds_read_b64_tr_b16 v[94:95], v11 offset:31840
    v_mfma_f32_16x16x32_bf16 v[148:151], v[36:39], v[240:243], v[148:151]
    ds_read_b64_tr_b16 v[120:121], v11 offset:38560
    v_mfma_f32_16x16x32_bf16 v[204:207], v[36:39], v[244:247], v[204:207]
    ds_read_b64_tr_b16 v[122:123], v11 offset:39520
    v_mfma_f32_16x16x32_bf16 v[176:179], v[64:67], v[240:243], v[176:179]
    ds_read_b64_tr_b16 v[96:97], v11 offset:30912
    v_mfma_f32_16x16x32_bf16 v[232:235], v[64:67], v[244:247], v[232:235]
    ds_read_b64_tr_b16 v[98:99], v11 offset:31872
    v_mfma_f32_16x16x32_bf16 v[152:155], v[40:43], v[240:243], v[152:155]
    ds_read_b64_tr_b16 v[124:125], v11 offset:38592
    v_mfma_f32_16x16x32_bf16 v[208:211], v[40:43], v[244:247], v[208:211]
    ds_read_b64_tr_b16 v[126:127], v11 offset:39552
    v_mfma_f32_16x16x32_bf16 v[180:183], v[68:71], v[240:243], v[180:183]
    v_mfma_f32_16x16x32_bf16 v[236:239], v[68:71], v[244:247], v[236:239]
    s_waitcnt vmcnt(4)
    s_waitcnt lgkmcnt(0)
    s_barrier
    v_mfma_f32_16x16x32_bf16 v[128:131], v[72:75], v[248:251], v[128:131]
    ds_read_b128 v[240:243], v14 offset:16384
    ds_read_b128 v[244:247], v14 offset:18432
    v_mfma_f32_16x16x32_bf16 v[184:187], v[72:75], v[252:255], v[184:187]
    ds_read_b64_tr_b16 v[16:17], v11 offset:0
    ds_read_b64_tr_b16 v[18:19], v11 offset:960
    s_mov_b32 s66, 512
    s_add_u32 m0, s74, 0
    s_nop 0
    buffer_load_dwordx4 v12, s[12:15], s66 offen sc1 lds
    v_mfma_f32_16x16x32_bf16 v[156:159], v[100:103], v[248:251], v[156:159]
    ds_read_b64_tr_b16 v[44:45], v11 offset:7680
    ds_read_b64_tr_b16 v[46:47], v11 offset:8640
    v_mfma_f32_16x16x32_bf16 v[212:215], v[100:103], v[252:255], v[212:215]
    ds_read_b64_tr_b16 v[20:21], v11 offset:32
    ds_read_b64_tr_b16 v[22:23], v11 offset:992
    v_mfma_f32_16x16x32_bf16 v[132:135], v[76:79], v[248:251], v[132:135]
    ds_read_b64_tr_b16 v[48:49], v11 offset:7712
    s_mov_b32 s66, 8704
    s_add_u32 m0, s74, 1024
    s_nop 0
    buffer_load_dwordx4 v13, s[12:15], s66 offen sc1 lds
    v_mfma_f32_16x16x32_bf16 v[188:191], v[76:79], v[252:255], v[188:191]
    ds_read_b64_tr_b16 v[50:51], v11 offset:8672
    v_mfma_f32_16x16x32_bf16 v[160:163], v[104:107], v[248:251], v[160:163]
    ds_read_b64_tr_b16 v[24:25], v11 offset:64
    v_mfma_f32_16x16x32_bf16 v[216:219], v[104:107], v[252:255], v[216:219]
    ds_read_b64_tr_b16 v[26:27], v11 offset:1024
    s_mov_b32 s66, 16896
    s_add_u32 m0, s74, 2048
    s_nop 0
    buffer_load_dwordx4 v12, s[12:15], s66 offen sc1 lds
    v_mfma_f32_16x16x32_bf16 v[136:139], v[80:83], v[248:251], v[136:139]
    ds_read_b64_tr_b16 v[52:53], v11 offset:7744
    v_mfma_f32_16x16x32_bf16 v[192:195], v[80:83], v[252:255], v[192:195]
    ds_read_b64_tr_b16 v[54:55], v11 offset:8704
    v_mfma_f32_16x16x32_bf16 v[164:167], v[108:111], v[248:251], v[164:167]
    ds_read_b64_tr_b16 v[28:29], v11 offset:96
    s_mov_b32 s66, 25088
    s_add_u32 m0, s74, 3072
    s_nop 0
    buffer_load_dwordx4 v13, s[12:15], s66 offen sc1 lds
    v_mfma_f32_16x16x32_bf16 v[220:223], v[108:111], v[252:255], v[220:223]
    ds_read_b64_tr_b16 v[30:31], v11 offset:1056
    v_mfma_f32_16x16x32_bf16 v[140:143], v[84:87], v[248:251], v[140:143]
    ds_read_b64_tr_b16 v[56:57], v11 offset:7776
    v_mfma_f32_16x16x32_bf16 v[196:199], v[84:87], v[252:255], v[196:199]
    ds_read_b64_tr_b16 v[58:59], v11 offset:8736
    s_add_u32 s66, s72, 917504
    s_add_u32 m0, s73, 30720
    s_mov_b32 exec_hi, 0x00ffffff
    buffer_load_dwordx4 v10, s[28:31], s66 offen lds
    s_mov_b32 exec_hi, -1
    v_mfma_f32_16x16x32_bf16 v[168:171], v[112:115], v[248:251], v[168:171]
    ds_read_b64_tr_b16 v[32:33], v11 offset:128
    v_mfma_f32_16x16x32_bf16 v[224:227], v[112:115], v[252:255], v[224:227]
    ds_read_b64_tr_b16 v[34:35], v11 offset:1088
    v_mfma_f32_16x16x32_bf16 v[144:147], v[88:91], v[248:251], v[144:147]
    ds_read_b64_tr_b16 v[60:61], v11 offset:7808
    s_add_u32 s66, s72, 931840
    s_add_u32 m0, s73, 31680
    s_mov_b32 exec_hi, 0x00ffffff
    buffer_load_dwordx4 v10, s[28:31], s66 offen lds
    s_mov_b32 exec_hi, -1
    v_mfma_f32_16x16x32_bf16 v[200:203], v[88:91], v[252:255], v[200:203]
    ds_read_b64_tr_b16 v[62:63], v11 offset:8768
    v_mfma_f32_16x16x32_bf16 v[172:175], v[116:119], v[248:251], v[172:175]
    ds_read_b64_tr_b16 v[36:37], v11 offset:160
    v_mfma_f32_16x16x32_bf16 v[228:231], v[116:119], v[252:255], v[228:231]
    ds_read_b64_tr_b16 v[38:39], v11 offset:1120
    s_add_u32 s66, s72, 917504
    s_add_u32 m0, s73, 38400
    s_mov_b32 exec_hi, 0x00ffffff
    buffer_load_dwordx4 v10, s[32:35], s66 offen lds
    s_mov_b32 exec_hi, -1
    v_mfma_f32_16x16x32_bf16 v[148:151], v[92:95], v[248:251], v[148:151]
    ds_read_b64_tr_b16 v[64:65], v11 offset:7840
    v_mfma_f32_16x16x32_bf16 v[204:207], v[92:95], v[252:255], v[204:207]
    ds_read_b64_tr_b16 v[66:67], v11 offset:8800
    v_mfma_f32_16x16x32_bf16 v[176:179], v[120:123], v[248:251], v[176:179]
    ds_read_b64_tr_b16 v[40:41], v11 offset:192
    s_add_u32 s66, s72, 931840
    s_add_u32 m0, s73, 39360
    s_mov_b32 exec_hi, 0x00ffffff
    buffer_load_dwordx4 v10, s[32:35], s66 offen lds
    s_mov_b32 exec_hi, -1
    v_mfma_f32_16x16x32_bf16 v[232:235], v[120:123], v[252:255], v[232:235]
    ds_read_b64_tr_b16 v[42:43], v11 offset:1152
    v_mfma_f32_16x16x32_bf16 v[152:155], v[96:99], v[248:251], v[152:155]
    ds_read_b64_tr_b16 v[68:69], v11 offset:7872
    v_mfma_f32_16x16x32_bf16 v[208:211], v[96:99], v[252:255], v[208:211]
    ds_read_b64_tr_b16 v[70:71], v11 offset:8832
    v_mfma_f32_16x16x32_bf16 v[180:183], v[124:127], v[248:251], v[180:183]
    v_mfma_f32_16x16x32_bf16 v[236:239], v[124:127], v[252:255], v[236:239]
    s_waitcnt vmcnt(8)
    s_waitcnt lgkmcnt(0)
    s_barrier
    v_mfma_f32_16x16x32_bf16 v[128:131], v[16:19], v[240:243], v[128:131]
    ds_read_b128 v[248:251], v15 offset:16384
    ds_read_b128 v[252:255], v15 offset:18432
    v_mfma_f32_16x16x32_bf16 v[184:187], v[16:19], v[244:247], v[184:187]
    ds_read_b64_tr_b16 v[72:73], v11 offset:15360
    ds_read_b64_tr_b16 v[74:75], v11 offset:16320
    s_add_u32 s66, s72, 1032192
    s_add_u32 m0, s73, 0
    s_mov_b32 exec_hi, 0x00ffffff
    buffer_load_dwordx4 v10, s[28:31], s66 offen lds
    s_mov_b32 exec_hi, -1
    v_mfma_f32_16x16x32_bf16 v[156:159], v[44:47], v[240:243], v[156:159]
    ds_read_b64_tr_b16 v[100:101], v11 offset:23040
    ds_read_b64_tr_b16 v[102:103], v11 offset:24000
    v_mfma_f32_16x16x32_bf16 v[212:215], v[44:47], v[244:247], v[212:215]
    ds_read_b64_tr_b16 v[76:77], v11 offset:15392
    ds_read_b64_tr_b16 v[78:79], v11 offset:16352
    v_mfma_f32_16x16x32_bf16 v[132:135], v[20:23], v[240:243], v[132:135]
    ds_read_b64_tr_b16 v[104:105], v11 offset:23072
    s_add_u32 s66, s72, 1046528
    s_add_u32 m0, s73, 960
    s_mov_b32 exec_hi, 0x00ffffff
    buffer_load_dwordx4 v10, s[28:31], s66 offen lds
    s_mov_b32 exec_hi, -1
    v_mfma_f32_16x16x32_bf16 v[188:191], v[20:23], v[244:247], v[188:191]
    ds_read_b64_tr_b16 v[106:107], v11 offset:24032
    v_mfma_f32_16x16x32_bf16 v[160:163], v[48:51], v[240:243], v[160:163]
    ds_read_b64_tr_b16 v[80:81], v11 offset:15424
    v_mfma_f32_16x16x32_bf16 v[216:219], v[48:51], v[244:247], v[216:219]
    ds_read_b64_tr_b16 v[82:83], v11 offset:16384
    s_add_u32 s66, s72, 1032192
    s_add_u32 m0, s73, 7680
    s_mov_b32 exec_hi, 0x00ffffff
    buffer_load_dwordx4 v10, s[32:35], s66 offen lds
    s_mov_b32 exec_hi, -1
    v_mfma_f32_16x16x32_bf16 v[136:139], v[24:27], v[240:243], v[136:139]
    ds_read_b64_tr_b16 v[108:109], v11 offset:23104
    v_mfma_f32_16x16x32_bf16 v[192:195], v[24:27], v[244:247], v[192:195]
    ds_read_b64_tr_b16 v[110:111], v11 offset:24064
    v_mfma_f32_16x16x32_bf16 v[164:167], v[52:55], v[240:243], v[164:167]
    ds_read_b64_tr_b16 v[84:85], v11 offset:15456
    s_add_u32 s66, s72, 1046528
    s_add_u32 m0, s73, 8640
    s_mov_b32 exec_hi, 0x00ffffff
    buffer_load_dwordx4 v10, s[32:35], s66 offen lds
    s_mov_b32 exec_hi, -1
    v_mfma_f32_16x16x32_bf16 v[220:223], v[52:55], v[244:247], v[220:223]
    ds_read_b64_tr_b16 v[86:87], v11 offset:16416
    v_mfma_f32_16x16x32_bf16 v[140:143], v[28:31], v[240:243], v[140:143]
    ds_read_b64_tr_b16 v[112:113], v11 offset:23136
    v_mfma_f32_16x16x32_bf16 v[196:199], v[28:31], v[244:247], v[196:199]
    ds_read_b64_tr_b16 v[114:115], v11 offset:24096
    v_mfma_f32_16x16x32_bf16 v[168:171], v[56:59], v[240:243], v[168:171]
    ds_read_b64_tr_b16 v[88:89], v11 offset:15488
    v_mfma_f32_16x16x32_bf16 v[224:227], v[56:59], v[244:247], v[224:227]
    ds_read_b64_tr_b16 v[90:91], v11 offset:16448
    v_mfma_f32_16x16x32_bf16 v[144:147], v[32:35], v[240:243], v[144:147]
    ds_read_b64_tr_b16 v[116:117], v11 offset:23168
    v_mfma_f32_16x16x32_bf16 v[200:203], v[32:35], v[244:247], v[200:203]
    ds_read_b64_tr_b16 v[118:119], v11 offset:24128
    v_mfma_f32_16x16x32_bf16 v[172:175], v[60:63], v[240:243], v[172:175]
    ds_read_b64_tr_b16 v[92:93], v11 offset:15520
    v_mfma_f32_16x16x32_bf16 v[228:231], v[60:63], v[244:247], v[228:231]
    ds_read_b64_tr_b16 v[94:95], v11 offset:16480
    v_mfma_f32_16x16x32_bf16 v[148:151], v[36:39], v[240:243], v[148:151]
    ds_read_b64_tr_b16 v[120:121], v11 offset:23200
    v_mfma_f32_16x16x32_bf16 v[204:207], v[36:39], v[244:247], v[204:207]
    ds_read_b64_tr_b16 v[122:123], v11 offset:24160
    v_mfma_f32_16x16x32_bf16 v[176:179], v[64:67], v[240:243], v[176:179]
    ds_read_b64_tr_b16 v[96:97], v11 offset:15552
    v_mfma_f32_16x16x32_bf16 v[232:235], v[64:67], v[244:247], v[232:235]
    ds_read_b64_tr_b16 v[98:99], v11 offset:16512
    v_mfma_f32_16x16x32_bf16 v[152:155], v[40:43], v[240:243], v[152:155]
    ds_read_b64_tr_b16 v[124:125], v11 offset:23232
    v_mfma_f32_16x16x32_bf16 v[208:211], v[40:43], v[244:247], v[208:211]
    ds_read_b64_tr_b16 v[126:127], v11 offset:24192
    v_mfma_f32_16x16x32_bf16 v[180:183], v[68:71], v[240:243], v[180:183]
    v_mfma_f32_16x16x32_bf16 v[236:239], v[68:71], v[244:247], v[236:239]
    s_waitcnt vmcnt(4)
    s_waitcnt lgkmcnt(0)
    s_barrier
    v_mfma_f32_16x16x32_bf16 v[128:131], v[72:75], v[248:251], v[128:131]
    ds_read_b128 v[240:243], v14 offset:0
    ds_read_b128 v[244:247], v14 offset:2048
    v_mfma_f32_16x16x32_bf16 v[184:187], v[72:75], v[252:255], v[184:187]
    ds_read_b64_tr_b16 v[16:17], v11 offset:30720
    ds_read_b64_tr_b16 v[18:19], v11 offset:31680
    s_mov_b32 s66, 640
    s_add_u32 m0, s74, 16384
    s_nop 0
    buffer_load_dwordx4 v12, s[12:15], s66 offen sc1 lds
    v_mfma_f32_16x16x32_bf16 v[156:159], v[100:103], v[248:251], v[156:159]
    ds_read_b64_tr_b16 v[44:45], v11 offset:38400
    ds_read_b64_tr_b16 v[46:47], v11 offset:39360
    v_mfma_f32_16x16x32_bf16 v[212:215], v[100:103], v[252:255], v[212:215]
    ds_read_b64_tr_b16 v[20:21], v11 offset:30752
    ds_read_b64_tr_b16 v[22:23], v11 offset:31712
    v_mfma_f32_16x16x32_bf16 v[132:135], v[76:79], v[248:251], v[132:135]
    ds_read_b64_tr_b16 v[48:49], v11 offset:38432
    s_mov_b32 s66, 8832
    s_add_u32 m0, s74, 17408
    s_nop 0
    buffer_load_dwordx4 v13, s[12:15], s66 offen sc1 lds
    v_mfma_f32_16x16x32_bf16 v[188:191], v[76:79], v[252:255], v[188:191]
    ds_read_b64_tr_b16 v[50:51], v11 offset:39392
    v_mfma_f32_16x16x32_bf16 v[160:163], v[104:107], v[248:251], v[160:163]
    ds_read_b64_tr_b16 v[24:25], v11 offset:30784
    v_mfma_f32_16x16x32_bf16 v[216:219], v[104:107], v[252:255], v[216:219]
    ds_read_b64_tr_b16 v[26:27], v11 offset:31744
    s_mov_b32 s66, 17024
    s_add_u32 m0, s74, 18432
    s_nop 0
    buffer_load_dwordx4 v12, s[12:15], s66 offen sc1 lds
    v_mfma_f32_16x16x32_bf16 v[136:139], v[80:83], v[248:251], v[136:139]
    ds_read_b64_tr_b16 v[52:53], v11 offset:38464
    v_mfma_f32_16x16x32_bf16 v[192:195], v[80:83], v[252:255], v[192:195]
    ds_read_b64_tr_b16 v[54:55], v11 offset:39424
    v_mfma_f32_16x16x32_bf16 v[164:167], v[108:111], v[248:251], v[164:167]
    ds_read_b64_tr_b16 v[28:29], v11 offset:30816
    s_mov_b32 s66, 25216
    s_add_u32 m0, s74, 19456
    s_nop 0
    buffer_load_dwordx4 v13, s[12:15], s66 offen sc1 lds
    v_mfma_f32_16x16x32_bf16 v[220:223], v[108:111], v[252:255], v[220:223]
    ds_read_b64_tr_b16 v[30:31], v11 offset:31776
    v_mfma_f32_16x16x32_bf16 v[140:143], v[84:87], v[248:251], v[140:143]
    ds_read_b64_tr_b16 v[56:57], v11 offset:38496
    v_mfma_f32_16x16x32_bf16 v[196:199], v[84:87], v[252:255], v[196:199]
    ds_read_b64_tr_b16 v[58:59], v11 offset:39456
    s_add_u32 s66, s72, 1146880
    s_add_u32 m0, s73, 15360
    s_mov_b32 exec_hi, 0x00ffffff
    buffer_load_dwordx4 v10, s[28:31], s66 offen lds
    s_mov_b32 exec_hi, -1
    v_mfma_f32_16x16x32_bf16 v[168:171], v[112:115], v[248:251], v[168:171]
    ds_read_b64_tr_b16 v[32:33], v11 offset:30848
    v_mfma_f32_16x16x32_bf16 v[224:227], v[112:115], v[252:255], v[224:227]
    ds_read_b64_tr_b16 v[34:35], v11 offset:31808
    v_mfma_f32_16x16x32_bf16 v[144:147], v[88:91], v[248:251], v[144:147]
    ds_read_b64_tr_b16 v[60:61], v11 offset:38528
    s_add_u32 s66, s72, 1161216
    s_add_u32 m0, s73, 16320
    s_mov_b32 exec_hi, 0x00ffffff
    buffer_load_dwordx4 v10, s[28:31], s66 offen lds
    s_mov_b32 exec_hi, -1
    v_mfma_f32_16x16x32_bf16 v[200:203], v[88:91], v[252:255], v[200:203]
    ds_read_b64_tr_b16 v[62:63], v11 offset:39488
    v_mfma_f32_16x16x32_bf16 v[172:175], v[116:119], v[248:251], v[172:175]
    ds_read_b64_tr_b16 v[36:37], v11 offset:30880
    v_mfma_f32_16x16x32_bf16 v[228:231], v[116:119], v[252:255], v[228:231]
    ds_read_b64_tr_b16 v[38:39], v11 offset:31840
    s_add_u32 s66, s72, 1146880
    s_add_u32 m0, s73, 23040
    s_mov_b32 exec_hi, 0x00ffffff
    buffer_load_dwordx4 v10, s[32:35], s66 offen lds
    s_mov_b32 exec_hi, -1
    v_mfma_f32_16x16x32_bf16 v[148:151], v[92:95], v[248:251], v[148:151]
    ds_read_b64_tr_b16 v[64:65], v11 offset:38560
    v_mfma_f32_16x16x32_bf16 v[204:207], v[92:95], v[252:255], v[204:207]
    ds_read_b64_tr_b16 v[66:67], v11 offset:39520
    v_mfma_f32_16x16x32_bf16 v[176:179], v[120:123], v[248:251], v[176:179]
    ds_read_b64_tr_b16 v[40:41], v11 offset:30912
    s_add_u32 s66, s72, 1161216
    s_add_u32 m0, s73, 24000
    s_mov_b32 exec_hi, 0x00ffffff
    buffer_load_dwordx4 v10, s[32:35], s66 offen lds
    s_mov_b32 exec_hi, -1
    v_mfma_f32_16x16x32_bf16 v[232:235], v[120:123], v[252:255], v[232:235]
    ds_read_b64_tr_b16 v[42:43], v11 offset:31872
    v_mfma_f32_16x16x32_bf16 v[152:155], v[96:99], v[248:251], v[152:155]
    ds_read_b64_tr_b16 v[68:69], v11 offset:38592
    v_mfma_f32_16x16x32_bf16 v[208:211], v[96:99], v[252:255], v[208:211]
    ds_read_b64_tr_b16 v[70:71], v11 offset:39552
    v_mfma_f32_16x16x32_bf16 v[180:183], v[124:127], v[248:251], v[180:183]
    v_mfma_f32_16x16x32_bf16 v[236:239], v[124:127], v[252:255], v[236:239]
    s_waitcnt vmcnt(8)
    s_waitcnt lgkmcnt(0)
    s_barrier
    v_mfma_f32_16x16x32_bf16 v[128:131], v[16:19], v[240:243], v[128:131]
    ds_read_b128 v[248:251], v15 offset:0
    ds_read_b128 v[252:255], v15 offset:2048
    v_mfma_f32_16x16x32_bf16 v[184:187], v[16:19], v[244:247], v[184:187]
    ds_read_b64_tr_b16 v[72:73], v11 offset:0
    ds_read_b64_tr_b16 v[74:75], v11 offset:960
    s_add_u32 s66, s72, 1261568
    s_add_u32 m0, s73, 30720
    s_mov_b32 exec_hi, 0x00ffffff
    buffer_load_dwordx4 v10, s[28:31], s66 offen lds
    s_mov_b32 exec_hi, -1
    v_mfma_f32_16x16x32_bf16 v[156:159], v[44:47], v[240:243], v[156:159]
    ds_read_b64_tr_b16 v[100:101], v11 offset:7680
    ds_read_b64_tr_b16 v[102:103], v11 offset:8640
    v_mfma_f32_16x16x32_bf16 v[212:215], v[44:47], v[244:247], v[212:215]
    ds_read_b64_tr_b16 v[76:77], v11 offset:32
    ds_read_b64_tr_b16 v[78:79], v11 offset:992
    v_mfma_f32_16x16x32_bf16 v[132:135], v[20:23], v[240:243], v[132:135]
    ds_read_b64_tr_b16 v[104:105], v11 offset:7712
    s_add_u32 s66, s72, 1275904
    s_add_u32 m0, s73, 31680
    s_mov_b32 exec_hi, 0x00ffffff
    buffer_load_dwordx4 v10, s[28:31], s66 offen lds
    s_mov_b32 exec_hi, -1
    v_mfma_f32_16x16x32_bf16 v[188:191], v[20:23], v[244:247], v[188:191]
    ds_read_b64_tr_b16 v[106:107], v11 offset:8672
    v_mfma_f32_16x16x32_bf16 v[160:163], v[48:51], v[240:243], v[160:163]
    ds_read_b64_tr_b16 v[80:81], v11 offset:64
    v_mfma_f32_16x16x32_bf16 v[216:219], v[48:51], v[244:247], v[216:219]
    ds_read_b64_tr_b16 v[82:83], v11 offset:1024
    s_add_u32 s66, s72, 1261568
    s_add_u32 m0, s73, 38400
    s_mov_b32 exec_hi, 0x00ffffff
    buffer_load_dwordx4 v10, s[32:35], s66 offen lds
    s_mov_b32 exec_hi, -1
    v_mfma_f32_16x16x32_bf16 v[136:139], v[24:27], v[240:243], v[136:139]
    ds_read_b64_tr_b16 v[108:109], v11 offset:7744
    v_mfma_f32_16x16x32_bf16 v[192:195], v[24:27], v[244:247], v[192:195]
    ds_read_b64_tr_b16 v[110:111], v11 offset:8704
    v_mfma_f32_16x16x32_bf16 v[164:167], v[52:55], v[240:243], v[164:167]
    ds_read_b64_tr_b16 v[84:85], v11 offset:96
    s_add_u32 s66, s72, 1275904
    s_add_u32 m0, s73, 39360
    s_mov_b32 exec_hi, 0x00ffffff
    buffer_load_dwordx4 v10, s[32:35], s66 offen lds
    s_mov_b32 exec_hi, -1
    v_mfma_f32_16x16x32_bf16 v[220:223], v[52:55], v[244:247], v[220:223]
    ds_read_b64_tr_b16 v[86:87], v11 offset:1056
    v_mfma_f32_16x16x32_bf16 v[140:143], v[28:31], v[240:243], v[140:143]
    ds_read_b64_tr_b16 v[112:113], v11 offset:7776
    v_mfma_f32_16x16x32_bf16 v[196:199], v[28:31], v[244:247], v[196:199]
    ds_read_b64_tr_b16 v[114:115], v11 offset:8736
    v_mfma_f32_16x16x32_bf16 v[168:171], v[56:59], v[240:243], v[168:171]
    ds_read_b64_tr_b16 v[88:89], v11 offset:128
    v_mfma_f32_16x16x32_bf16 v[224:227], v[56:59], v[244:247], v[224:227]
    ds_read_b64_tr_b16 v[90:91], v11 offset:1088
    v_mfma_f32_16x16x32_bf16 v[144:147], v[32:35], v[240:243], v[144:147]
    ds_read_b64_tr_b16 v[116:117], v11 offset:7808
    v_mfma_f32_16x16x32_bf16 v[200:203], v[32:35], v[244:247], v[200:203]
    ds_read_b64_tr_b16 v[118:119], v11 offset:8768
    v_mfma_f32_16x16x32_bf16 v[172:175], v[60:63], v[240:243], v[172:175]
    ds_read_b64_tr_b16 v[92:93], v11 offset:160
    v_mfma_f32_16x16x32_bf16 v[228:231], v[60:63], v[244:247], v[228:231]
    ds_read_b64_tr_b16 v[94:95], v11 offset:1120
    v_mfma_f32_16x16x32_bf16 v[148:151], v[36:39], v[240:243], v[148:151]
    ds_read_b64_tr_b16 v[120:121], v11 offset:7840
    v_mfma_f32_16x16x32_bf16 v[204:207], v[36:39], v[244:247], v[204:207]
    ds_read_b64_tr_b16 v[122:123], v11 offset:8800
    v_mfma_f32_16x16x32_bf16 v[176:179], v[64:67], v[240:243], v[176:179]
    ds_read_b64_tr_b16 v[96:97], v11 offset:192
    v_mfma_f32_16x16x32_bf16 v[232:235], v[64:67], v[244:247], v[232:235]
    ds_read_b64_tr_b16 v[98:99], v11 offset:1152
    v_mfma_f32_16x16x32_bf16 v[152:155], v[40:43], v[240:243], v[152:155]
    ds_read_b64_tr_b16 v[124:125], v11 offset:7872
    v_mfma_f32_16x16x32_bf16 v[208:211], v[40:43], v[244:247], v[208:211]
    ds_read_b64_tr_b16 v[126:127], v11 offset:8832
    v_mfma_f32_16x16x32_bf16 v[180:183], v[68:71], v[240:243], v[180:183]
    v_mfma_f32_16x16x32_bf16 v[236:239], v[68:71], v[244:247], v[236:239]
    s_waitcnt vmcnt(4)
    s_waitcnt lgkmcnt(0)
    s_barrier
    v_mfma_f32_16x16x32_bf16 v[128:131], v[72:75], v[248:251], v[128:131]
    ds_read_b128 v[240:243], v14 offset:16384
    ds_read_b128 v[244:247], v14 offset:18432
    v_mfma_f32_16x16x32_bf16 v[184:187], v[72:75], v[252:255], v[184:187]
    ds_read_b64_tr_b16 v[16:17], v11 offset:15360
    ds_read_b64_tr_b16 v[18:19], v11 offset:16320
    s_mov_b32 s66, 768
    s_add_u32 m0, s74, 0
    s_nop 0
    buffer_load_dwordx4 v12, s[12:15], s66 offen sc1 lds
    v_mfma_f32_16x16x32_bf16 v[156:159], v[100:103], v[248:251], v[156:159]
    ds_read_b64_tr_b16 v[44:45], v11 offset:23040
    ds_read_b64_tr_b16 v[46:47], v11 offset:24000
    v_mfma_f32_16x16x32_bf16 v[212:215], v[100:103], v[252:255], v[212:215]
    ds_read_b64_tr_b16 v[20:21], v11 offset:15392
    ds_read_b64_tr_b16 v[22:23], v11 offset:16352
    v_mfma_f32_16x16x32_bf16 v[132:135], v[76:79], v[248:251], v[132:135]
    ds_read_b64_tr_b16 v[48:49], v11 offset:23072
    s_mov_b32 s66, 8960
    s_add_u32 m0, s74, 1024
    s_nop 0
    buffer_load_dwordx4 v13, s[12:15], s66 offen sc1 lds
    v_mfma_f32_16x16x32_bf16 v[188:191], v[76:79], v[252:255], v[188:191]
    ds_read_b64_tr_b16 v[50:51], v11 offset:24032
    v_mfma_f32_16x16x32_bf16 v[160:163], v[104:107], v[248:251], v[160:163]
    ds_read_b64_tr_b16 v[24:25], v11 offset:15424
    v_mfma_f32_16x16x32_bf16 v[216:219], v[104:107], v[252:255], v[216:219]
    ds_read_b64_tr_b16 v[26:27], v11 offset:16384
    s_mov_b32 s66, 17152
    s_add_u32 m0, s74, 2048
    s_nop 0
    buffer_load_dwordx4 v12, s[12:15], s66 offen sc1 lds
    v_mfma_f32_16x16x32_bf16 v[136:139], v[80:83], v[248:251], v[136:139]
    ds_read_b64_tr_b16 v[52:53], v11 offset:23104
    v_mfma_f32_16x16x32_bf16 v[192:195], v[80:83], v[252:255], v[192:195]
    ds_read_b64_tr_b16 v[54:55], v11 offset:24064
    v_mfma_f32_16x16x32_bf16 v[164:167], v[108:111], v[248:251], v[164:167]
    ds_read_b64_tr_b16 v[28:29], v11 offset:15456
    s_mov_b32 s66, 25344
    s_add_u32 m0, s74, 3072
    s_nop 0
    buffer_load_dwordx4 v13, s[12:15], s66 offen sc1 lds
    v_mfma_f32_16x16x32_bf16 v[220:223], v[108:111], v[252:255], v[220:223]
    ds_read_b64_tr_b16 v[30:31], v11 offset:16416
    v_mfma_f32_16x16x32_bf16 v[140:143], v[84:87], v[248:251], v[140:143]
    ds_read_b64_tr_b16 v[56:57], v11 offset:23136
    v_mfma_f32_16x16x32_bf16 v[196:199], v[84:87], v[252:255], v[196:199]
    ds_read_b64_tr_b16 v[58:59], v11 offset:24096
    s_add_u32 s66, s72, 1376256
    s_add_u32 m0, s73, 0
    s_mov_b32 exec_hi, 0x00ffffff
    buffer_load_dwordx4 v10, s[28:31], s66 offen lds
    s_mov_b32 exec_hi, -1
    v_mfma_f32_16x16x32_bf16 v[168:171], v[112:115], v[248:251], v[168:171]
    ds_read_b64_tr_b16 v[32:33], v11 offset:15488
    v_mfma_f32_16x16x32_bf16 v[224:227], v[112:115], v[252:255], v[224:227]
    ds_read_b64_tr_b16 v[34:35], v11 offset:16448
    v_mfma_f32_16x16x32_bf16 v[144:147], v[88:91], v[248:251], v[144:147]
    ds_read_b64_tr_b16 v[60:61], v11 offset:23168
    s_add_u32 s66, s72, 1390592
    s_add_u32 m0, s73, 960
    s_mov_b32 exec_hi, 0x00ffffff
    buffer_load_dwordx4 v10, s[28:31], s66 offen lds
    s_mov_b32 exec_hi, -1
    v_mfma_f32_16x16x32_bf16 v[200:203], v[88:91], v[252:255], v[200:203]
    ds_read_b64_tr_b16 v[62:63], v11 offset:24128
    v_mfma_f32_16x16x32_bf16 v[172:175], v[116:119], v[248:251], v[172:175]
    ds_read_b64_tr_b16 v[36:37], v11 offset:15520
    v_mfma_f32_16x16x32_bf16 v[228:231], v[116:119], v[252:255], v[228:231]
    ds_read_b64_tr_b16 v[38:39], v11 offset:16480
    s_add_u32 s66, s72, 1376256
    s_add_u32 m0, s73, 7680
    s_mov_b32 exec_hi, 0x00ffffff
    buffer_load_dwordx4 v10, s[32:35], s66 offen lds
    s_mov_b32 exec_hi, -1
    v_mfma_f32_16x16x32_bf16 v[148:151], v[92:95], v[248:251], v[148:151]
    ds_read_b64_tr_b16 v[64:65], v11 offset:23200
    v_mfma_f32_16x16x32_bf16 v[204:207], v[92:95], v[252:255], v[204:207]
    ds_read_b64_tr_b16 v[66:67], v11 offset:24160
    v_mfma_f32_16x16x32_bf16 v[176:179], v[120:123], v[248:251], v[176:179]
    ds_read_b64_tr_b16 v[40:41], v11 offset:15552
    s_add_u32 s66, s72, 1390592
    s_add_u32 m0, s73, 8640
    s_mov_b32 exec_hi, 0x00ffffff
    buffer_load_dwordx4 v10, s[32:35], s66 offen lds
    s_mov_b32 exec_hi, -1
    v_mfma_f32_16x16x32_bf16 v[232:235], v[120:123], v[252:255], v[232:235]
    ds_read_b64_tr_b16 v[42:43], v11 offset:16512
    v_mfma_f32_16x16x32_bf16 v[152:155], v[96:99], v[248:251], v[152:155]
    ds_read_b64_tr_b16 v[68:69], v11 offset:23232
    v_mfma_f32_16x16x32_bf16 v[208:211], v[96:99], v[252:255], v[208:211]
    ds_read_b64_tr_b16 v[70:71], v11 offset:24192
    v_mfma_f32_16x16x32_bf16 v[180:183], v[124:127], v[248:251], v[180:183]
    v_mfma_f32_16x16x32_bf16 v[236:239], v[124:127], v[252:255], v[236:239]
    s_waitcnt vmcnt(8)
    s_waitcnt lgkmcnt(0)
    s_barrier
    v_mfma_f32_16x16x32_bf16 v[128:131], v[16:19], v[240:243], v[128:131]
    ds_read_b128 v[248:251], v15 offset:16384
    ds_read_b128 v[252:255], v15 offset:18432
    v_mfma_f32_16x16x32_bf16 v[184:187], v[16:19], v[244:247], v[184:187]
    ds_read_b64_tr_b16 v[72:73], v11 offset:30720
    ds_read_b64_tr_b16 v[74:75], v11 offset:31680
    s_add_u32 s66, s72, 1490944
    s_add_u32 m0, s73, 15360
    s_mov_b32 exec_hi, 0x00ffffff
    buffer_load_dwordx4 v10, s[28:31], s66 offen lds
    s_mov_b32 exec_hi, -1
    v_mfma_f32_16x16x32_bf16 v[156:159], v[44:47], v[240:243], v[156:159]
    ds_read_b64_tr_b16 v[100:101], v11 offset:38400
    ds_read_b64_tr_b16 v[102:103], v11 offset:39360
    v_mfma_f32_16x16x32_bf16 v[212:215], v[44:47], v[244:247], v[212:215]
    ds_read_b64_tr_b16 v[76:77], v11 offset:30752
    ds_read_b64_tr_b16 v[78:79], v11 offset:31712
    v_mfma_f32_16x16x32_bf16 v[132:135], v[20:23], v[240:243], v[132:135]
    ds_read_b64_tr_b16 v[104:105], v11 offset:38432
    s_add_u32 s66, s72, 1505280
    s_add_u32 m0, s73, 16320
    s_mov_b32 exec_hi, 0x00ffffff
    buffer_load_dwordx4 v10, s[28:31], s66 offen lds
    s_mov_b32 exec_hi, -1
    v_mfma_f32_16x16x32_bf16 v[188:191], v[20:23], v[244:247], v[188:191]
    ds_read_b64_tr_b16 v[106:107], v11 offset:39392
    v_mfma_f32_16x16x32_bf16 v[160:163], v[48:51], v[240:243], v[160:163]
    ds_read_b64_tr_b16 v[80:81], v11 offset:30784
    v_mfma_f32_16x16x32_bf16 v[216:219], v[48:51], v[244:247], v[216:219]
    ds_read_b64_tr_b16 v[82:83], v11 offset:31744
    s_add_u32 s66, s72, 1490944
    s_add_u32 m0, s73, 23040
    s_mov_b32 exec_hi, 0x00ffffff
    buffer_load_dwordx4 v10, s[32:35], s66 offen lds
    s_mov_b32 exec_hi, -1
    v_mfma_f32_16x16x32_bf16 v[136:139], v[24:27], v[240:243], v[136:139]
    ds_read_b64_tr_b16 v[108:109], v11 offset:38464
    v_mfma_f32_16x16x32_bf16 v[192:195], v[24:27], v[244:247], v[192:195]
    ds_read_b64_tr_b16 v[110:111], v11 offset:39424
    v_mfma_f32_16x16x32_bf16 v[164:167], v[52:55], v[240:243], v[164:167]
    ds_read_b64_tr_b16 v[84:85], v11 offset:30816
    s_add_u32 s66, s72, 1505280
    s_add_u32 m0, s73, 24000
    s_mov_b32 exec_hi, 0x00ffffff
    buffer_load_dwordx4 v10, s[32:35], s66 offen lds
    s_mov_b32 exec_hi, -1
    v_mfma_f32_16x16x32_bf16 v[220:223], v[52:55], v[244:247], v[220:223]
    ds_read_b64_tr_b16 v[86:87], v11 offset:31776
    v_mfma_f32_16x16x32_bf16 v[140:143], v[28:31], v[240:243], v[140:143]
    ds_read_b64_tr_b16 v[112:113], v11 offset:38496
    v_mfma_f32_16x16x32_bf16 v[196:199], v[28:31], v[244:247], v[196:199]
    ds_read_b64_tr_b16 v[114:115], v11 offset:39456
    v_mfma_f32_16x16x32_bf16 v[168:171], v[56:59], v[240:243], v[168:171]
    ds_read_b64_tr_b16 v[88:89], v11 offset:30848
    v_mfma_f32_16x16x32_bf16 v[224:227], v[56:59], v[244:247], v[224:227]
    ds_read_b64_tr_b16 v[90:91], v11 offset:31808
    v_mfma_f32_16x16x32_bf16 v[144:147], v[32:35], v[240:243], v[144:147]
    ds_read_b64_tr_b16 v[116:117], v11 offset:38528
    v_mfma_f32_16x16x32_bf16 v[200:203], v[32:35], v[244:247], v[200:203]
    ds_read_b64_tr_b16 v[118:119], v11 offset:39488
    v_mfma_f32_16x16x32_bf16 v[172:175], v[60:63], v[240:243], v[172:175]
    ds_read_b64_tr_b16 v[92:93], v11 offset:30880
    v_mfma_f32_16x16x32_bf16 v[228:231], v[60:63], v[244:247], v[228:231]
    ds_read_b64_tr_b16 v[94:95], v11 offset:31840
    v_mfma_f32_16x16x32_bf16 v[148:151], v[36:39], v[240:243], v[148:151]
    ds_read_b64_tr_b16 v[120:121], v11 offset:38560
    v_mfma_f32_16x16x32_bf16 v[204:207], v[36:39], v[244:247], v[204:207]
    ds_read_b64_tr_b16 v[122:123], v11 offset:39520
    v_mfma_f32_16x16x32_bf16 v[176:179], v[64:67], v[240:243], v[176:179]
    ds_read_b64_tr_b16 v[96:97], v11 offset:30912
    v_mfma_f32_16x16x32_bf16 v[232:235], v[64:67], v[244:247], v[232:235]
    ds_read_b64_tr_b16 v[98:99], v11 offset:31872
    v_mfma_f32_16x16x32_bf16 v[152:155], v[40:43], v[240:243], v[152:155]
    ds_read_b64_tr_b16 v[124:125], v11 offset:38592
    v_mfma_f32_16x16x32_bf16 v[208:211], v[40:43], v[244:247], v[208:211]
    ds_read_b64_tr_b16 v[126:127], v11 offset:39552
    v_mfma_f32_16x16x32_bf16 v[180:183], v[68:71], v[240:243], v[180:183]
    v_mfma_f32_16x16x32_bf16 v[236:239], v[68:71], v[244:247], v[236:239]
    s_waitcnt vmcnt(4)
    s_waitcnt lgkmcnt(0)
    s_barrier
    v_mfma_f32_16x16x32_bf16 v[128:131], v[72:75], v[248:251], v[128:131]
    ds_read_b128 v[240:243], v14 offset:0
    ds_read_b128 v[244:247], v14 offset:2048
    v_mfma_f32_16x16x32_bf16 v[184:187], v[72:75], v[252:255], v[184:187]
    ds_read_b64_tr_b16 v[16:17], v11 offset:0
    ds_read_b64_tr_b16 v[18:19], v11 offset:960
    s_mov_b32 s66, 896
    s_add_u32 m0, s74, 16384
    s_nop 0
    buffer_load_dwordx4 v12, s[12:15], s66 offen sc1 lds
    v_mfma_f32_16x16x32_bf16 v[156:159], v[100:103], v[248:251], v[156:159]
    ds_read_b64_tr_b16 v[44:45], v11 offset:7680
    ds_read_b64_tr_b16 v[46:47], v11 offset:8640
    v_mfma_f32_16x16x32_bf16 v[212:215], v[100:103], v[252:255], v[212:215]
    ds_read_b64_tr_b16 v[20:21], v11 offset:32
    ds_read_b64_tr_b16 v[22:23], v11 offset:992
    v_mfma_f32_16x16x32_bf16 v[132:135], v[76:79], v[248:251], v[132:135]
    ds_read_b64_tr_b16 v[48:49], v11 offset:7712
    s_mov_b32 s66, 9088
    s_add_u32 m0, s74, 17408
    s_nop 0
    buffer_load_dwordx4 v13, s[12:15], s66 offen sc1 lds
    v_mfma_f32_16x16x32_bf16 v[188:191], v[76:79], v[252:255], v[188:191]
    ds_read_b64_tr_b16 v[50:51], v11 offset:8672
    v_mfma_f32_16x16x32_bf16 v[160:163], v[104:107], v[248:251], v[160:163]
    ds_read_b64_tr_b16 v[24:25], v11 offset:64
    v_mfma_f32_16x16x32_bf16 v[216:219], v[104:107], v[252:255], v[216:219]
    ds_read_b64_tr_b16 v[26:27], v11 offset:1024
    s_mov_b32 s66, 17280
    s_add_u32 m0, s74, 18432
    s_nop 0
    buffer_load_dwordx4 v12, s[12:15], s66 offen sc1 lds
    v_mfma_f32_16x16x32_bf16 v[136:139], v[80:83], v[248:251], v[136:139]
    ds_read_b64_tr_b16 v[52:53], v11 offset:7744
    v_mfma_f32_16x16x32_bf16 v[192:195], v[80:83], v[252:255], v[192:195]
    ds_read_b64_tr_b16 v[54:55], v11 offset:8704
    v_mfma_f32_16x16x32_bf16 v[164:167], v[108:111], v[248:251], v[164:167]
    ds_read_b64_tr_b16 v[28:29], v11 offset:96
    s_mov_b32 s66, 25472
    s_add_u32 m0, s74, 19456
    s_nop 0
    buffer_load_dwordx4 v13, s[12:15], s66 offen sc1 lds
    v_mfma_f32_16x16x32_bf16 v[220:223], v[108:111], v[252:255], v[220:223]
    ds_read_b64_tr_b16 v[30:31], v11 offset:1056
    v_mfma_f32_16x16x32_bf16 v[140:143], v[84:87], v[248:251], v[140:143]
    ds_read_b64_tr_b16 v[56:57], v11 offset:7776
    v_mfma_f32_16x16x32_bf16 v[196:199], v[84:87], v[252:255], v[196:199]
    ds_read_b64_tr_b16 v[58:59], v11 offset:8736
    s_add_u32 s66, s72, 1605632
    s_add_u32 m0, s73, 30720
    s_mov_b32 exec_hi, 0x00ffffff
    buffer_load_dwordx4 v10, s[28:31], s66 offen lds
    s_mov_b32 exec_hi, -1
    v_mfma_f32_16x16x32_bf16 v[168:171], v[112:115], v[248:251], v[168:171]
    ds_read_b64_tr_b16 v[32:33], v11 offset:128
    v_mfma_f32_16x16x32_bf16 v[224:227], v[112:115], v[252:255], v[224:227]
    ds_read_b64_tr_b16 v[34:35], v11 offset:1088
    v_mfma_f32_16x16x32_bf16 v[144:147], v[88:91], v[248:251], v[144:147]
    ds_read_b64_tr_b16 v[60:61], v11 offset:7808
    s_add_u32 s66, s72, 1619968
    s_add_u32 m0, s73, 31680
    s_mov_b32 exec_hi, 0x00ffffff
    buffer_load_dwordx4 v10, s[28:31], s66 offen lds
    s_mov_b32 exec_hi, -1
    v_mfma_f32_16x16x32_bf16 v[200:203], v[88:91], v[252:255], v[200:203]
    ds_read_b64_tr_b16 v[62:63], v11 offset:8768
    v_mfma_f32_16x16x32_bf16 v[172:175], v[116:119], v[248:251], v[172:175]
    ds_read_b64_tr_b16 v[36:37], v11 offset:160
    v_mfma_f32_16x16x32_bf16 v[228:231], v[116:119], v[252:255], v[228:231]
    ds_read_b64_tr_b16 v[38:39], v11 offset:1120
    s_add_u32 s66, s72, 1605632
    s_add_u32 m0, s73, 38400
    s_mov_b32 exec_hi, 0x00ffffff
    buffer_load_dwordx4 v10, s[32:35], s66 offen lds
    s_mov_b32 exec_hi, -1
    v_mfma_f32_16x16x32_bf16 v[148:151], v[92:95], v[248:251], v[148:151]
    ds_read_b64_tr_b16 v[64:65], v11 offset:7840
    v_mfma_f32_16x16x32_bf16 v[204:207], v[92:95], v[252:255], v[204:207]
    ds_read_b64_tr_b16 v[66:67], v11 offset:8800
    v_mfma_f32_16x16x32_bf16 v[176:179], v[120:123], v[248:251], v[176:179]
    ds_read_b64_tr_b16 v[40:41], v11 offset:192
    s_add_u32 s66, s72, 1619968
    s_add_u32 m0, s73, 39360
    s_mov_b32 exec_hi, 0x00ffffff
    buffer_load_dwordx4 v10, s[32:35], s66 offen lds
    s_mov_b32 exec_hi, -1
    v_mfma_f32_16x16x32_bf16 v[232:235], v[120:123], v[252:255], v[232:235]
    ds_read_b64_tr_b16 v[42:43], v11 offset:1152
    v_mfma_f32_16x16x32_bf16 v[152:155], v[96:99], v[248:251], v[152:155]
    ds_read_b64_tr_b16 v[68:69], v11 offset:7872
    v_mfma_f32_16x16x32_bf16 v[208:211], v[96:99], v[252:255], v[208:211]
    ds_read_b64_tr_b16 v[70:71], v11 offset:8832
    v_mfma_f32_16x16x32_bf16 v[180:183], v[124:127], v[248:251], v[180:183]
    v_mfma_f32_16x16x32_bf16 v[236:239], v[124:127], v[252:255], v[236:239]
    s_waitcnt vmcnt(8)
    s_waitcnt lgkmcnt(0)
    s_barrier
    v_mfma_f32_16x16x32_bf16 v[128:131], v[16:19], v[240:243], v[128:131]
    ds_read_b128 v[248:251], v15 offset:0
    ds_read_b128 v[252:255], v15 offset:2048
    v_mfma_f32_16x16x32_bf16 v[184:187], v[16:19], v[244:247], v[184:187]
    ds_read_b64_tr_b16 v[72:73], v11 offset:15360
    ds_read_b64_tr_b16 v[74:75], v11 offset:16320
    s_add_u32 s66, s72, 1720320
    s_add_u32 m0, s73, 0
    s_mov_b32 exec_hi, 0x00ffffff
    buffer_load_dwordx4 v10, s[28:31], s66 offen lds
    s_mov_b32 exec_hi, -1
    v_mfma_f32_16x16x32_bf16 v[156:159], v[44:47], v[240:243], v[156:159]
    ds_read_b64_tr_b16 v[100:101], v11 offset:23040
    ds_read_b64_tr_b16 v[102:103], v11 offset:24000
    v_mfma_f32_16x16x32_bf16 v[212:215], v[44:47], v[244:247], v[212:215]
    ds_read_b64_tr_b16 v[76:77], v11 offset:15392
    ds_read_b64_tr_b16 v[78:79], v11 offset:16352
    v_mfma_f32_16x16x32_bf16 v[132:135], v[20:23], v[240:243], v[132:135]
    ds_read_b64_tr_b16 v[104:105], v11 offset:23072
    s_add_u32 s66, s72, 1734656
    s_add_u32 m0, s73, 960
    s_mov_b32 exec_hi, 0x00ffffff
    buffer_load_dwordx4 v10, s[28:31], s66 offen lds
    s_mov_b32 exec_hi, -1
    v_mfma_f32_16x16x32_bf16 v[188:191], v[20:23], v[244:247], v[188:191]
    ds_read_b64_tr_b16 v[106:107], v11 offset:24032
    v_mfma_f32_16x16x32_bf16 v[160:163], v[48:51], v[240:243], v[160:163]
    ds_read_b64_tr_b16 v[80:81], v11 offset:15424
    v_mfma_f32_16x16x32_bf16 v[216:219], v[48:51], v[244:247], v[216:219]
    ds_read_b64_tr_b16 v[82:83], v11 offset:16384
    s_add_u32 s66, s72, 1720320
    s_add_u32 m0, s73, 7680
    s_mov_b32 exec_hi, 0x00ffffff
    buffer_load_dwordx4 v10, s[32:35], s66 offen lds
    s_mov_b32 exec_hi, -1
    v_mfma_f32_16x16x32_bf16 v[136:139], v[24:27], v[240:243], v[136:139]
    ds_read_b64_tr_b16 v[108:109], v11 offset:23104
    v_mfma_f32_16x16x32_bf16 v[192:195], v[24:27], v[244:247], v[192:195]
    ds_read_b64_tr_b16 v[110:111], v11 offset:24064
    v_mfma_f32_16x16x32_bf16 v[164:167], v[52:55], v[240:243], v[164:167]
    ds_read_b64_tr_b16 v[84:85], v11 offset:15456
    s_add_u32 s66, s72, 1734656
    s_add_u32 m0, s73, 8640
    s_mov_b32 exec_hi, 0x00ffffff
    buffer_load_dwordx4 v10, s[32:35], s66 offen lds
    s_mov_b32 exec_hi, -1
    v_mfma_f32_16x16x32_bf16 v[220:223], v[52:55], v[244:247], v[220:223]
    ds_read_b64_tr_b16 v[86:87], v11 offset:16416
    v_mfma_f32_16x16x32_bf16 v[140:143], v[28:31], v[240:243], v[140:143]
    ds_read_b64_tr_b16 v[112:113], v11 offset:23136
    v_mfma_f32_16x16x32_bf16 v[196:199], v[28:31], v[244:247], v[196:199]
    ds_read_b64_tr_b16 v[114:115], v11 offset:24096
    v_mfma_f32_16x16x32_bf16 v[168:171], v[56:59], v[240:243], v[168:171]
    ds_read_b64_tr_b16 v[88:89], v11 offset:15488
    v_mfma_f32_16x16x32_bf16 v[224:227], v[56:59], v[244:247], v[224:227]
    ds_read_b64_tr_b16 v[90:91], v11 offset:16448
    v_mfma_f32_16x16x32_bf16 v[144:147], v[32:35], v[240:243], v[144:147]
    ds_read_b64_tr_b16 v[116:117], v11 offset:23168
    v_mfma_f32_16x16x32_bf16 v[200:203], v[32:35], v[244:247], v[200:203]
    ds_read_b64_tr_b16 v[118:119], v11 offset:24128
    v_mfma_f32_16x16x32_bf16 v[172:175], v[60:63], v[240:243], v[172:175]
    ds_read_b64_tr_b16 v[92:93], v11 offset:15520
    v_mfma_f32_16x16x32_bf16 v[228:231], v[60:63], v[244:247], v[228:231]
    ds_read_b64_tr_b16 v[94:95], v11 offset:16480
    v_mfma_f32_16x16x32_bf16 v[148:151], v[36:39], v[240:243], v[148:151]
    ds_read_b64_tr_b16 v[120:121], v11 offset:23200
    v_mfma_f32_16x16x32_bf16 v[204:207], v[36:39], v[244:247], v[204:207]
    ds_read_b64_tr_b16 v[122:123], v11 offset:24160
    v_mfma_f32_16x16x32_bf16 v[176:179], v[64:67], v[240:243], v[176:179]
    ds_read_b64_tr_b16 v[96:97], v11 offset:15552
    v_mfma_f32_16x16x32_bf16 v[232:235], v[64:67], v[244:247], v[232:235]
    ds_read_b64_tr_b16 v[98:99], v11 offset:16512
    v_mfma_f32_16x16x32_bf16 v[152:155], v[40:43], v[240:243], v[152:155]
    ds_read_b64_tr_b16 v[124:125], v11 offset:23232
    v_mfma_f32_16x16x32_bf16 v[208:211], v[40:43], v[244:247], v[208:211]
    ds_read_b64_tr_b16 v[126:127], v11 offset:24192
    v_mfma_f32_16x16x32_bf16 v[180:183], v[68:71], v[240:243], v[180:183]
    v_mfma_f32_16x16x32_bf16 v[236:239], v[68:71], v[244:247], v[236:239]
    s_waitcnt vmcnt(4)
    s_waitcnt lgkmcnt(0)
    s_barrier
    v_mfma_f32_16x16x32_bf16 v[128:131], v[72:75], v[248:251], v[128:131]
    ds_read_b128 v[240:243], v14 offset:16384
    ds_read_b128 v[244:247], v14 offset:18432
    v_mfma_f32_16x16x32_bf16 v[184:187], v[72:75], v[252:255], v[184:187]
    ds_read_b64_tr_b16 v[16:17], v11 offset:30720
    ds_read_b64_tr_b16 v[18:19], v11 offset:31680
    v_mfma_f32_16x16x32_bf16 v[156:159], v[100:103], v[248:251], v[156:159]
    ds_read_b64_tr_b16 v[44:45], v11 offset:38400
    ds_read_b64_tr_b16 v[46:47], v11 offset:39360
    v_mfma_f32_16x16x32_bf16 v[212:215], v[100:103], v[252:255], v[212:215]
    ds_read_b64_tr_b16 v[20:21], v11 offset:30752
    ds_read_b64_tr_b16 v[22:23], v11 offset:31712
    v_mfma_f32_16x16x32_bf16 v[132:135], v[76:79], v[248:251], v[132:135]
    ds_read_b64_tr_b16 v[48:49], v11 offset:38432
    v_mfma_f32_16x16x32_bf16 v[188:191], v[76:79], v[252:255], v[188:191]
    ds_read_b64_tr_b16 v[50:51], v11 offset:39392
    v_mfma_f32_16x16x32_bf16 v[160:163], v[104:107], v[248:251], v[160:163]
    ds_read_b64_tr_b16 v[24:25], v11 offset:30784
    v_mfma_f32_16x16x32_bf16 v[216:219], v[104:107], v[252:255], v[216:219]
    ds_read_b64_tr_b16 v[26:27], v11 offset:31744
    v_mfma_f32_16x16x32_bf16 v[136:139], v[80:83], v[248:251], v[136:139]
    ds_read_b64_tr_b16 v[52:53], v11 offset:38464
    v_mfma_f32_16x16x32_bf16 v[192:195], v[80:83], v[252:255], v[192:195]
    ds_read_b64_tr_b16 v[54:55], v11 offset:39424
    v_mfma_f32_16x16x32_bf16 v[164:167], v[108:111], v[248:251], v[164:167]
    ds_read_b64_tr_b16 v[28:29], v11 offset:30816
    v_mfma_f32_16x16x32_bf16 v[220:223], v[108:111], v[252:255], v[220:223]
    ds_read_b64_tr_b16 v[30:31], v11 offset:31776
    v_mfma_f32_16x16x32_bf16 v[140:143], v[84:87], v[248:251], v[140:143]
    ds_read_b64_tr_b16 v[56:57], v11 offset:38496
    v_mfma_f32_16x16x32_bf16 v[196:199], v[84:87], v[252:255], v[196:199]
    ds_read_b64_tr_b16 v[58:59], v11 offset:39456
    v_mfma_f32_16x16x32_bf16 v[168:171], v[112:115], v[248:251], v[168:171]
    ds_read_b64_tr_b16 v[32:33], v11 offset:30848
    v_mfma_f32_16x16x32_bf16 v[224:227], v[112:115], v[252:255], v[224:227]
    ds_read_b64_tr_b16 v[34:35], v11 offset:31808
    v_mfma_f32_16x16x32_bf16 v[144:147], v[88:91], v[248:251], v[144:147]
    ds_read_b64_tr_b16 v[60:61], v11 offset:38528
    v_mfma_f32_16x16x32_bf16 v[200:203], v[88:91], v[252:255], v[200:203]
    ds_read_b64_tr_b16 v[62:63], v11 offset:39488
    v_mfma_f32_16x16x32_bf16 v[172:175], v[116:119], v[248:251], v[172:175]
    ds_read_b64_tr_b16 v[36:37], v11 offset:30880
    v_mfma_f32_16x16x32_bf16 v[228:231], v[116:119], v[252:255], v[228:231]
    ds_read_b64_tr_b16 v[38:39], v11 offset:31840
    v_mfma_f32_16x16x32_bf16 v[148:151], v[92:95], v[248:251], v[148:151]
    ds_read_b64_tr_b16 v[64:65], v11 offset:38560
    v_mfma_f32_16x16x32_bf16 v[204:207], v[92:95], v[252:255], v[204:207]
    ds_read_b64_tr_b16 v[66:67], v11 offset:39520
    v_mfma_f32_16x16x32_bf16 v[176:179], v[120:123], v[248:251], v[176:179]
    ds_read_b64_tr_b16 v[40:41], v11 offset:30912
    v_mfma_f32_16x16x32_bf16 v[232:235], v[120:123], v[252:255], v[232:235]
    ds_read_b64_tr_b16 v[42:43], v11 offset:31872
    v_mfma_f32_16x16x32_bf16 v[152:155], v[96:99], v[248:251], v[152:155]
    ds_read_b64_tr_b16 v[68:69], v11 offset:38592
    v_mfma_f32_16x16x32_bf16 v[208:211], v[96:99], v[252:255], v[208:211]
    ds_read_b64_tr_b16 v[70:71], v11 offset:39552
    v_mfma_f32_16x16x32_bf16 v[180:183], v[124:127], v[248:251], v[180:183]
    v_mfma_f32_16x16x32_bf16 v[236:239], v[124:127], v[252:255], v[236:239]
    s_waitcnt vmcnt(0)
    s_waitcnt lgkmcnt(0)
    s_barrier
    v_mfma_f32_16x16x32_bf16 v[128:131], v[16:19], v[240:243], v[128:131]
    ds_read_b128 v[248:251], v15 offset:16384
    ds_read_b128 v[252:255], v15 offset:18432
    v_mfma_f32_16x16x32_bf16 v[184:187], v[16:19], v[244:247], v[184:187]
    ds_read_b64_tr_b16 v[72:73], v11 offset:0
    ds_read_b64_tr_b16 v[74:75], v11 offset:960
    v_mfma_f32_16x16x32_bf16 v[156:159], v[44:47], v[240:243], v[156:159]
    ds_read_b64_tr_b16 v[100:101], v11 offset:7680
    ds_read_b64_tr_b16 v[102:103], v11 offset:8640
    v_mfma_f32_16x16x32_bf16 v[212:215], v[44:47], v[244:247], v[212:215]
    ds_read_b64_tr_b16 v[76:77], v11 offset:32
    ds_read_b64_tr_b16 v[78:79], v11 offset:992
    v_mfma_f32_16x16x32_bf16 v[132:135], v[20:23], v[240:243], v[132:135]
    ds_read_b64_tr_b16 v[104:105], v11 offset:7712
    v_mfma_f32_16x16x32_bf16 v[188:191], v[20:23], v[244:247], v[188:191]
    ds_read_b64_tr_b16 v[106:107], v11 offset:8672
    v_mfma_f32_16x16x32_bf16 v[160:163], v[48:51], v[240:243], v[160:163]
    ds_read_b64_tr_b16 v[80:81], v11 offset:64
    v_mfma_f32_16x16x32_bf16 v[216:219], v[48:51], v[244:247], v[216:219]
    ds_read_b64_tr_b16 v[82:83], v11 offset:1024
    v_mfma_f32_16x16x32_bf16 v[136:139], v[24:27], v[240:243], v[136:139]
    ds_read_b64_tr_b16 v[108:109], v11 offset:7744
    v_mfma_f32_16x16x32_bf16 v[192:195], v[24:27], v[244:247], v[192:195]
    ds_read_b64_tr_b16 v[110:111], v11 offset:8704
    v_mfma_f32_16x16x32_bf16 v[164:167], v[52:55], v[240:243], v[164:167]
    ds_read_b64_tr_b16 v[84:85], v11 offset:96
    v_mfma_f32_16x16x32_bf16 v[220:223], v[52:55], v[244:247], v[220:223]
    ds_read_b64_tr_b16 v[86:87], v11 offset:1056
    v_mfma_f32_16x16x32_bf16 v[140:143], v[28:31], v[240:243], v[140:143]
    ds_read_b64_tr_b16 v[112:113], v11 offset:7776
    v_mfma_f32_16x16x32_bf16 v[196:199], v[28:31], v[244:247], v[196:199]
    ds_read_b64_tr_b16 v[114:115], v11 offset:8736
    v_mfma_f32_16x16x32_bf16 v[168:171], v[56:59], v[240:243], v[168:171]
    ds_read_b64_tr_b16 v[88:89], v11 offset:128
    v_mfma_f32_16x16x32_bf16 v[224:227], v[56:59], v[244:247], v[224:227]
    ds_read_b64_tr_b16 v[90:91], v11 offset:1088
    v_mfma_f32_16x16x32_bf16 v[144:147], v[32:35], v[240:243], v[144:147]
    ds_read_b64_tr_b16 v[116:117], v11 offset:7808
    v_mfma_f32_16x16x32_bf16 v[200:203], v[32:35], v[244:247], v[200:203]
    ds_read_b64_tr_b16 v[118:119], v11 offset:8768
    v_mfma_f32_16x16x32_bf16 v[172:175], v[60:63], v[240:243], v[172:175]
    ds_read_b64_tr_b16 v[92:93], v11 offset:160
    v_mfma_f32_16x16x32_bf16 v[228:231], v[60:63], v[244:247], v[228:231]
    ds_read_b64_tr_b16 v[94:95], v11 offset:1120
    v_mfma_f32_16x16x32_bf16 v[148:151], v[36:39], v[240:243], v[148:151]
    ds_read_b64_tr_b16 v[120:121], v11 offset:7840
    v_mfma_f32_16x16x32_bf16 v[204:207], v[36:39], v[244:247], v[204:207]
    ds_read_b64_tr_b16 v[122:123], v11 offset:8800
    v_mfma_f32_16x16x32_bf16 v[176:179], v[64:67], v[240:243], v[176:179]
    ds_read_b64_tr_b16 v[96:97], v11 offset:192
    v_mfma_f32_16x16x32_bf16 v[232:235], v[64:67], v[244:247], v[232:235]
    ds_read_b64_tr_b16 v[98:99], v11 offset:1152
    v_mfma_f32_16x16x32_bf16 v[152:155], v[40:43], v[240:243], v[152:155]
    ds_read_b64_tr_b16 v[124:125], v11 offset:7872
    v_mfma_f32_16x16x32_bf16 v[208:211], v[40:43], v[244:247], v[208:211]
    ds_read_b64_tr_b16 v[126:127], v11 offset:8832
    v_mfma_f32_16x16x32_bf16 v[180:183], v[68:71], v[240:243], v[180:183]
    v_mfma_f32_16x16x32_bf16 v[236:239], v[68:71], v[244:247], v[236:239]
    s_waitcnt lgkmcnt(0)
    s_barrier
    v_mfma_f32_16x16x32_bf16 v[128:131], v[72:75], v[248:251], v[128:131]
    v_mfma_f32_16x16x32_bf16 v[184:187], v[72:75], v[252:255], v[184:187]
    v_mfma_f32_16x16x32_bf16 v[156:159], v[100:103], v[248:251], v[156:159]
    v_mfma_f32_16x16x32_bf16 v[212:215], v[100:103], v[252:255], v[212:215]
    v_mfma_f32_16x16x32_bf16 v[132:135], v[76:79], v[248:251], v[132:135]
    v_mfma_f32_16x16x32_bf16 v[188:191], v[76:79], v[252:255], v[188:191]
    v_mfma_f32_16x16x32_bf16 v[160:163], v[104:107], v[248:251], v[160:163]
    v_mfma_f32_16x16x32_bf16 v[216:219], v[104:107], v[252:255], v[216:219]
    v_mfma_f32_16x16x32_bf16 v[136:139], v[80:83], v[248:251], v[136:139]
    v_mfma_f32_16x16x32_bf16 v[192:195], v[80:83], v[252:255], v[192:195]
    v_mfma_f32_16x16x32_bf16 v[164:167], v[108:111], v[248:251], v[164:167]
    v_mfma_f32_16x16x32_bf16 v[220:223], v[108:111], v[252:255], v[220:223]
    v_mfma_f32_16x16x32_bf16 v[140:143], v[84:87], v[248:251], v[140:143]
    v_mfma_f32_16x16x32_bf16 v[196:199], v[84:87], v[252:255], v[196:199]
    v_mfma_f32_16x16x32_bf16 v[168:171], v[112:115], v[248:251], v[168:171]
    v_mfma_f32_16x16x32_bf16 v[224:227], v[112:115], v[252:255], v[224:227]
    v_mfma_f32_16x16x32_bf16 v[144:147], v[88:91], v[248:251], v[144:147]
    v_mfma_f32_16x16x32_bf16 v[200:203], v[88:91], v[252:255], v[200:203]
    v_mfma_f32_16x16x32_bf16 v[172:175], v[116:119], v[248:251], v[172:175]
    v_mfma_f32_16x16x32_bf16 v[228:231], v[116:119], v[252:255], v[228:231]
    v_mfma_f32_16x16x32_bf16 v[148:151], v[92:95], v[248:251], v[148:151]
    v_mfma_f32_16x16x32_bf16 v[204:207], v[92:95], v[252:255], v[204:207]
    v_mfma_f32_16x16x32_bf16 v[176:179], v[120:123], v[248:251], v[176:179]
    v_mfma_f32_16x16x32_bf16 v[232:235], v[120:123], v[252:255], v[232:235]
    v_mfma_f32_16x16x32_bf16 v[152:155], v[96:99], v[248:251], v[152:155]
    v_mfma_f32_16x16x32_bf16 v[208:211], v[96:99], v[252:255], v[208:211]
    v_mfma_f32_16x16x32_bf16 v[180:183], v[124:127], v[248:251], v[180:183]
    v_mfma_f32_16x16x32_bf16 v[236:239], v[124:127], v[252:255], v[236:239]
    s_mov_b32 s66, 0xffff0000
    s_mov_b32 s67, 0xbfb8aa3b
    v_mul_u32_u24 v5, 240, v1
    v_lshl_add_u32 v5, v2, 3, v5
    v_add_u32 v5, s74, v5
    s_lshl_b32 s64, s70, 7
    s_lshl_b32 s65, s68, 5
    s_add_u32 s64, s64, s65
    s_mul_i32 s64, s64, 3584
    s_mul_i32 s65, s71, 224
    s_add_u32 s75, s64, s65
    s_add_u32 s76, s75, 57344
    v_add_u32 v6, 0, v4
    v_mul_u32_u24 v7, 0x2493, v6
    v_lshrrev_b32 v7, 17, v7
    v_mul_u32_u24 v9, 14, v7
    v_sub_u32 v9, v6, v9
    v_mul_u32_u24 v6, 3584, v7
    v_lshl_add_u32 v104, v9, 4, v6
    v_mul_u32_u24 v6, 240, v7
    v_lshl_add_u32 v6, v9, 4, v6
    v_add_u32 v108, s74, v6
    v_add_u32 v6, 64, v4
    v_mul_u32_u24 v7, 0x2493, v6
    v_lshrrev_b32 v7, 17, v7
    v_mul_u32_u24 v9, 14, v7
    v_sub_u32 v9, v6, v9
    v_mul_u32_u24 v6, 3584, v7
    v_lshl_add_u32 v105, v9, 4, v6
    v_mul_u32_u24 v6, 240, v7
    v_lshl_add_u32 v6, v9, 4, v6
    v_add_u32 v109, s74, v6
    v_add_u32 v6, 128, v4
    v_mul_u32_u24 v7, 0x2493, v6
    v_lshrrev_b32 v7, 17, v7
    v_mul_u32_u24 v9, 14, v7
    v_sub_u32 v9, v6, v9
    v_mul_u32_u24 v6, 3584, v7
    v_lshl_add_u32 v106, v9, 4, v6
    v_mul_u32_u24 v6, 240, v7
    v_lshl_add_u32 v6, v9, 4, v6
    v_add_u32 v110, s74, v6
    v_add_u32 v6, 192, v4
    v_mul_u32_u24 v7, 0x2493, v6
    v_lshrrev_b32 v7, 17, v7
    v_mul_u32_u24 v9, 14, v7
    v_sub_u32 v9, v6, v9
    v_mul_u32_u24 v6, 3584, v7
    v_lshl_add_u32 v107, v9, 4, v6
    v_mul_u32_u24 v6, 240, v7
    v_lshl_add_u32 v6, v9, 4, v6
    v_add_u32 v111, s74, v6
    v_cvt_pk_bf16_f32 v16, v128, v129
    v_cvt_pk_bf16_f32 v17, v130, v131
    v_lshlrev_b32 v18, 16, v16
    v_and_b32 v19, s66, v16
    v_lshlrev_b32 v20, 16, v17
    v_and_b32 v21, s66, v17
    v_mul_f32 v22, s67, v18
    v_mul_f32 v23, s67, v19
    v_mul_f32 v24, s67, v20
    v_mul_f32 v25, s67, v21
    v_exp_f32 v22, v22
    v_exp_f32 v23, v23
    v_exp_f32 v24, v24
    v_exp_f32 v25, v25
    v_cvt_pk_bf16_f32 v16, v156, v157
    v_cvt_pk_bf16_f32 v17, v158, v159
    v_lshlrev_b32 v26, 16, v16
    v_and_b32 v27, s66, v16
    v_lshlrev_b32 v28, 16, v17
    v_and_b32 v29, s66, v17
    v_add_f32 v22, 1.0, v22
    v_add_f32 v23, 1.0, v23
    v_add_f32 v24, 1.0, v24
    v_add_f32 v25, 1.0, v25
    v_rcp_f32 v22, v22
    v_rcp_f32 v23, v23
    v_rcp_f32 v24, v24
    v_rcp_f32 v25, v25
    v_mul_f32 v18, v18, v22
    v_mul_f32 v19, v19, v23
    v_mul_f32 v20, v20, v24
    v_mul_f32 v21, v21, v25
    v_cvt_pk_bf16_f32 v16, v18, v19
    v_cvt_pk_bf16_f32 v17, v20, v21
    v_lshlrev_b32 v18, 16, v16
    v_and_b32 v19, s66, v16
    v_lshlrev_b32 v20, 16, v17
    v_and_b32 v21, s66, v17
    v_mul_f32 v18, v18, v26
    v_mul_f32 v19, v19, v27
    v_mul_f32 v20, v20, v28
    v_mul_f32 v21, v21, v29
    v_cvt_pk_bf16_f32 v30, v18, v19
    v_cvt_pk_bf16_f32 v31, v20, v21
    ds_write_b64 v5, v[30:31] offset:0
    v_cvt_pk_bf16_f32 v32, v132, v133
    v_cvt_pk_bf16_f32 v33, v134, v135
    v_lshlrev_b32 v34, 16, v32
    v_and_b32 v35, s66, v32
    v_lshlrev_b32 v36, 16, v33
    v_and_b32 v37, s66, v33
    v_mul_f32 v38, s67, v34
    v_mul_f32 v39, s67, v35
    v_mul_f32 v40, s67, v36
    v_mul_f32 v41, s67, v37
    v_exp_f32 v38, v38
    v_exp_f32 v39, v39
    v_exp_f32 v40, v40
    v_exp_f32 v41, v41
    v_cvt_pk_bf16_f32 v32, v160, v161
    v_cvt_pk_bf16_f32 v33, v162, v163
    v_lshlrev_b32 v42, 16, v32
    v_and_b32 v43, s66, v32
    v_lshlrev_b32 v44, 16, v33
    v_and_b32 v45, s66, v33
    v_add_f32 v38, 1.0, v38
    v_add_f32 v39, 1.0, v39
    v_add_f32 v40, 1.0, v40
    v_add_f32 v41, 1.0, v41
    v_rcp_f32 v38, v38
    v_rcp_f32 v39, v39
    v_rcp_f32 v40, v40
    v_rcp_f32 v41, v41
    v_mul_f32 v34, v34, v38
    v_mul_f32 v35, v35, v39
    v_mul_f32 v36, v36, v40
    v_mul_f32 v37, v37, v41
    v_cvt_pk_bf16_f32 v32, v34, v35
    v_cvt_pk_bf16_f32 v33, v36, v37
    v_lshlrev_b32 v34, 16, v32
    v_and_b32 v35, s66, v32
    v_lshlrev_b32 v36, 16, v33
    v_and_b32 v37, s66, v33
    v_mul_f32 v34, v34, v42
    v_mul_f32 v35, v35, v43
    v_mul_f32 v36, v36, v44
    v_mul_f32 v37, v37, v45
    v_cvt_pk_bf16_f32 v46, v34, v35
    v_cvt_pk_bf16_f32 v47, v36, v37
    ds_write_b64 v5, v[46:47] offset:32
    v_cvt_pk_bf16_f32 v16, v136, v137
    v_cvt_pk_bf16_f32 v17, v138, v139
    v_lshlrev_b32 v18, 16, v16
    v_and_b32 v19, s66, v16
    v_lshlrev_b32 v20, 16, v17
    v_and_b32 v21, s66, v17
    v_mul_f32 v22, s67, v18
    v_mul_f32 v23, s67, v19
    v_mul_f32 v24, s67, v20
    v_mul_f32 v25, s67, v21
    v_exp_f32 v22, v22
    v_exp_f32 v23, v23
    v_exp_f32 v24, v24
    v_exp_f32 v25, v25
    v_cvt_pk_bf16_f32 v16, v164, v165
    v_cvt_pk_bf16_f32 v17, v166, v167
    v_lshlrev_b32 v26, 16, v16
    v_and_b32 v27, s66, v16
    v_lshlrev_b32 v28, 16, v17
    v_and_b32 v29, s66, v17
    v_add_f32 v22, 1.0, v22
    v_add_f32 v23, 1.0, v23
    v_add_f32 v24, 1.0, v24
    v_add_f32 v25, 1.0, v25
    v_rcp_f32 v22, v22
    v_rcp_f32 v23, v23
    v_rcp_f32 v24, v24
    v_rcp_f32 v25, v25
    v_mul_f32 v18, v18, v22
    v_mul_f32 v19, v19, v23
    v_mul_f32 v20, v20, v24
    v_mul_f32 v21, v21, v25
    v_cvt_pk_bf16_f32 v16, v18, v19
    v_cvt_pk_bf16_f32 v17, v20, v21
    v_lshlrev_b32 v18, 16, v16
    v_and_b32 v19, s66, v16
    v_lshlrev_b32 v20, 16, v17
    v_and_b32 v21, s66, v17
    v_mul_f32 v18, v18, v26
    v_mul_f32 v19, v19, v27
    v_mul_f32 v20, v20, v28
    v_mul_f32 v21, v21, v29
    v_cvt_pk_bf16_f32 v30, v18, v19
    v_cvt_pk_bf16_f32 v31, v20, v21
    ds_write_b64 v5, v[30:31] offset:64
    v_cvt_pk_bf16_f32 v32, v140, v141
    v_cvt_pk_bf16_f32 v33, v142, v143
    v_lshlrev_b32 v34, 16, v32
    v_and_b32 v35, s66, v32
    v_lshlrev_b32 v36, 16, v33
    v_and_b32 v37, s66, v33
    v_mul_f32 v38, s67, v34
    v_mul_f32 v39, s67, v35
    v_mul_f32 v40, s67, v36
    v_mul_f32 v41, s67, v37
    v_exp_f32 v38, v38
    v_exp_f32 v39, v39
    v_exp_f32 v40, v40
    v_exp_f32 v41, v41
    v_cvt_pk_bf16_f32 v32, v168, v169
    v_cvt_pk_bf16_f32 v33, v170, v171
    v_lshlrev_b32 v42, 16, v32
    v_and_b32 v43, s66, v32
    v_lshlrev_b32 v44, 16, v33
    v_and_b32 v45, s66, v33
    v_add_f32 v38, 1.0, v38
    v_add_f32 v39, 1.0, v39
    v_add_f32 v40, 1.0, v40
    v_add_f32 v41, 1.0, v41
    v_rcp_f32 v38, v38
    v_rcp_f32 v39, v39
    v_rcp_f32 v40, v40
    v_rcp_f32 v41, v41
    v_mul_f32 v34, v34, v38
    v_mul_f32 v35, v35, v39
    v_mul_f32 v36, v36, v40
    v_mul_f32 v37, v37, v41
    v_cvt_pk_bf16_f32 v32, v34, v35
    v_cvt_pk_bf16_f32 v33, v36, v37
    v_lshlrev_b32 v34, 16, v32
    v_and_b32 v35, s66, v32
    v_lshlrev_b32 v36, 16, v33
    v_and_b32 v37, s66, v33
    v_mul_f32 v34, v34, v42
    v_mul_f32 v35, v35, v43
    v_mul_f32 v36, v36, v44
    v_mul_f32 v37, v37, v45
    v_cvt_pk_bf16_f32 v46, v34, v35
    v_cvt_pk_bf16_f32 v47, v36, v37
    ds_write_b64 v5, v[46:47] offset:96
    v_cvt_pk_bf16_f32 v16, v144, v145
    v_cvt_pk_bf16_f32 v17, v146, v147
    v_lshlrev_b32 v18, 16, v16
    v_and_b32 v19, s66, v16
    v_lshlrev_b32 v20, 16, v17
    v_and_b32 v21, s66, v17
    v_mul_f32 v22, s67, v18
    v_mul_f32 v23, s67, v19
    v_mul_f32 v24, s67, v20
    v_mul_f32 v25, s67, v21
    v_exp_f32 v22, v22
    v_exp_f32 v23, v23
    v_exp_f32 v24, v24
    v_exp_f32 v25, v25
    v_cvt_pk_bf16_f32 v16, v172, v173
    v_cvt_pk_bf16_f32 v17, v174, v175
    v_lshlrev_b32 v26, 16, v16
    v_and_b32 v27, s66, v16
    v_lshlrev_b32 v28, 16, v17
    v_and_b32 v29, s66, v17
    v_add_f32 v22, 1.0, v22
    v_add_f32 v23, 1.0, v23
    v_add_f32 v24, 1.0, v24
    v_add_f32 v25, 1.0, v25
    v_rcp_f32 v22, v22
    v_rcp_f32 v23, v23
    v_rcp_f32 v24, v24
    v_rcp_f32 v25, v25
    v_mul_f32 v18, v18, v22
    v_mul_f32 v19, v19, v23
    v_mul_f32 v20, v20, v24
    v_mul_f32 v21, v21, v25
    v_cvt_pk_bf16_f32 v16, v18, v19
    v_cvt_pk_bf16_f32 v17, v20, v21
    v_lshlrev_b32 v18, 16, v16
    v_and_b32 v19, s66, v16
    v_lshlrev_b32 v20, 16, v17
    v_and_b32 v21, s66, v17
    v_mul_f32 v18, v18, v26
    v_mul_f32 v19, v19, v27
    v_mul_f32 v20, v20, v28
    v_mul_f32 v21, v21, v29
    v_cvt_pk_bf16_f32 v30, v18, v19
    v_cvt_pk_bf16_f32 v31, v20, v21
    ds_write_b64 v5, v[30:31] offset:128
    v_cvt_pk_bf16_f32 v32, v148, v149
    v_cvt_pk_bf16_f32 v33, v150, v151
    v_lshlrev_b32 v34, 16, v32
    v_and_b32 v35, s66, v32
    v_lshlrev_b32 v36, 16, v33
    v_and_b32 v37, s66, v33
    v_mul_f32 v38, s67, v34
    v_mul_f32 v39, s67, v35
    v_mul_f32 v40, s67, v36
    v_mul_f32 v41, s67, v37
    v_exp_f32 v38, v38
    v_exp_f32 v39, v39
    v_exp_f32 v40, v40
    v_exp_f32 v41, v41
    v_cvt_pk_bf16_f32 v32, v176, v177
    v_cvt_pk_bf16_f32 v33, v178, v179
    v_lshlrev_b32 v42, 16, v32
    v_and_b32 v43, s66, v32
    v_lshlrev_b32 v44, 16, v33
    v_and_b32 v45, s66, v33
    v_add_f32 v38, 1.0, v38
    v_add_f32 v39, 1.0, v39
    v_add_f32 v40, 1.0, v40
    v_add_f32 v41, 1.0, v41
    v_rcp_f32 v38, v38
    v_rcp_f32 v39, v39
    v_rcp_f32 v40, v40
    v_rcp_f32 v41, v41
    v_mul_f32 v34, v34, v38
    v_mul_f32 v35, v35, v39
    v_mul_f32 v36, v36, v40
    v_mul_f32 v37, v37, v41
    v_cvt_pk_bf16_f32 v32, v34, v35
    v_cvt_pk_bf16_f32 v33, v36, v37
    v_lshlrev_b32 v34, 16, v32
    v_and_b32 v35, s66, v32
    v_lshlrev_b32 v36, 16, v33
    v_and_b32 v37, s66, v33
    v_mul_f32 v34, v34, v42
    v_mul_f32 v35, v35, v43
    v_mul_f32 v36, v36, v44
    v_mul_f32 v37, v37, v45
    v_cvt_pk_bf16_f32 v46, v34, v35
    v_cvt_pk_bf16_f32 v47, v36, v37
    ds_write_b64 v5, v[46:47] offset:160
    v_cvt_pk_bf16_f32 v16, v152, v153
    v_cvt_pk_bf16_f32 v17, v154, v155
    v_lshlrev_b32 v18, 16, v16
    v_and_b32 v19, s66, v16
    v_lshlrev_b32 v20, 16, v17
    v_and_b32 v21, s66, v17
    v_mul_f32 v22, s67, v18
    v_mul_f32 v23, s67, v19
    v_mul_f32 v24, s67, v20
    v_mul_f32 v25, s67, v21
    v_exp_f32 v22, v22
    v_exp_f32 v23, v23
    v_exp_f32 v24, v24
    v_exp_f32 v25, v25
    v_cvt_pk_bf16_f32 v16, v180, v181
    v_cvt_pk_bf16_f32 v17, v182, v183
    v_lshlrev_b32 v26, 16, v16
    v_and_b32 v27, s66, v16
    v_lshlrev_b32 v28, 16, v17
    v_and_b32 v29, s66, v17
    v_add_f32 v22, 1.0, v22
    v_add_f32 v23, 1.0, v23
    v_add_f32 v24, 1.0, v24
    v_add_f32 v25, 1.0, v25
    v_rcp_f32 v22, v22
    v_rcp_f32 v23, v23
    v_rcp_f32 v24, v24
    v_rcp_f32 v25, v25
    v_mul_f32 v18, v18, v22
    v_mul_f32 v19, v19, v23
    v_mul_f32 v20, v20, v24
    v_mul_f32 v21, v21, v25
    v_cvt_pk_bf16_f32 v16, v18, v19
    v_cvt_pk_bf16_f32 v17, v20, v21
    v_lshlrev_b32 v18, 16, v16
    v_and_b32 v19, s66, v16
    v_lshlrev_b32 v20, 16, v17
    v_and_b32 v21, s66, v17
    v_mul_f32 v18, v18, v26
    v_mul_f32 v19, v19, v27
    v_mul_f32 v20, v20, v28
    v_mul_f32 v21, v21, v29
    v_cvt_pk_bf16_f32 v30, v18, v19
    v_cvt_pk_bf16_f32 v31, v20, v21
    ds_write_b64 v5, v[30:31] offset:192
    s_waitcnt lgkmcnt(0)
    ds_read_b128 v[112:115], v108 offset:0
    ds_read_b128 v[116:119], v109 offset:0
    ds_read_b128 v[120:123], v110 offset:0
    s_mov_b32 exec_hi, 0
    ds_read_b128 v[124:127], v111 offset:0
    s_mov_b32 exec_hi, -1
    s_waitcnt lgkmcnt(3)
    buffer_store_dwordx4 v[112:115], v104, s[20:23], s75 offen sc1
    s_waitcnt lgkmcnt(2)
    buffer_store_dwordx4 v[116:119], v105, s[20:23], s75 offen sc1
    s_waitcnt lgkmcnt(1)
    buffer_store_dwordx4 v[120:123], v106, s[20:23], s75 offen sc1
    s_waitcnt lgkmcnt(0)
    s_mov_b32 exec_hi, 0
    buffer_store_dwordx4 v[124:127], v107, s[20:23], s75 offen sc1
    s_mov_b32 exec_hi, -1
    v_cvt_pk_bf16_f32 v16, v184, v185
    v_cvt_pk_bf16_f32 v17, v186, v187
    v_lshlrev_b32 v18, 16, v16
    v_and_b32 v19, s66, v16
    v_lshlrev_b32 v20, 16, v17
    v_and_b32 v21, s66, v17
    v_mul_f32 v22, s67, v18
    v_mul_f32 v23, s67, v19
    v_mul_f32 v24, s67, v20
    v_mul_f32 v25, s67, v21
    v_exp_f32 v22, v22
    v_exp_f32 v23, v23
    v_exp_f32 v24, v24
    v_exp_f32 v25, v25
    v_cvt_pk_bf16_f32 v16, v212, v213
    v_cvt_pk_bf16_f32 v17, v214, v215
    v_lshlrev_b32 v26, 16, v16
    v_and_b32 v27, s66, v16
    v_lshlrev_b32 v28, 16, v17
    v_and_b32 v29, s66, v17
    v_add_f32 v22, 1.0, v22
    v_add_f32 v23, 1.0, v23
    v_add_f32 v24, 1.0, v24
    v_add_f32 v25, 1.0, v25
    v_rcp_f32 v22, v22
    v_rcp_f32 v23, v23
    v_rcp_f32 v24, v24
    v_rcp_f32 v25, v25
    v_mul_f32 v18, v18, v22
    v_mul_f32 v19, v19, v23
    v_mul_f32 v20, v20, v24
    v_mul_f32 v21, v21, v25
    v_cvt_pk_bf16_f32 v16, v18, v19
    v_cvt_pk_bf16_f32 v17, v20, v21
    v_lshlrev_b32 v18, 16, v16
    v_and_b32 v19, s66, v16
    v_lshlrev_b32 v20, 16, v17
    v_and_b32 v21, s66, v17
    v_mul_f32 v18, v18, v26
    v_mul_f32 v19, v19, v27
    v_mul_f32 v20, v20, v28
    v_mul_f32 v21, v21, v29
    v_cvt_pk_bf16_f32 v30, v18, v19
    v_cvt_pk_bf16_f32 v31, v20, v21
    ds_write_b64 v5, v[30:31] offset:16384
    v_cvt_pk_bf16_f32 v32, v188, v189
    v_cvt_pk_bf16_f32 v33, v190, v191
    v_lshlrev_b32 v34, 16, v32
    v_and_b32 v35, s66, v32
    v_lshlrev_b32 v36, 16, v33
    v_and_b32 v37, s66, v33
    v_mul_f32 v38, s67, v34
    v_mul_f32 v39, s67, v35
    v_mul_f32 v40, s67, v36
    v_mul_f32 v41, s67, v37
    v_exp_f32 v38, v38
    v_exp_f32 v39, v39
    v_exp_f32 v40, v40
    v_exp_f32 v41, v41
    v_cvt_pk_bf16_f32 v32, v216, v217
    v_cvt_pk_bf16_f32 v33, v218, v219
    v_lshlrev_b32 v42, 16, v32
    v_and_b32 v43, s66, v32
    v_lshlrev_b32 v44, 16, v33
    v_and_b32 v45, s66, v33
    v_add_f32 v38, 1.0, v38
    v_add_f32 v39, 1.0, v39
    v_add_f32 v40, 1.0, v40
    v_add_f32 v41, 1.0, v41
    v_rcp_f32 v38, v38
    v_rcp_f32 v39, v39
    v_rcp_f32 v40, v40
    v_rcp_f32 v41, v41
    v_mul_f32 v34, v34, v38
    v_mul_f32 v35, v35, v39
    v_mul_f32 v36, v36, v40
    v_mul_f32 v37, v37, v41
    v_cvt_pk_bf16_f32 v32, v34, v35
    v_cvt_pk_bf16_f32 v33, v36, v37
    v_lshlrev_b32 v34, 16, v32
    v_and_b32 v35, s66, v32
    v_lshlrev_b32 v36, 16, v33
    v_and_b32 v37, s66, v33
    v_mul_f32 v34, v34, v42
    v_mul_f32 v35, v35, v43
    v_mul_f32 v36, v36, v44
    v_mul_f32 v37, v37, v45
    v_cvt_pk_bf16_f32 v46, v34, v35
    v_cvt_pk_bf16_f32 v47, v36, v37
    ds_write_b64 v5, v[46:47] offset:16416
    v_cvt_pk_bf16_f32 v16, v192, v193
    v_cvt_pk_bf16_f32 v17, v194, v195
    v_lshlrev_b32 v18, 16, v16
    v_and_b32 v19, s66, v16
    v_lshlrev_b32 v20, 16, v17
    v_and_b32 v21, s66, v17
    v_mul_f32 v22, s67, v18
    v_mul_f32 v23, s67, v19
    v_mul_f32 v24, s67, v20
    v_mul_f32 v25, s67, v21
    v_exp_f32 v22, v22
    v_exp_f32 v23, v23
    v_exp_f32 v24, v24
    v_exp_f32 v25, v25
    v_cvt_pk_bf16_f32 v16, v220, v221
    v_cvt_pk_bf16_f32 v17, v222, v223
    v_lshlrev_b32 v26, 16, v16
    v_and_b32 v27, s66, v16
    v_lshlrev_b32 v28, 16, v17
    v_and_b32 v29, s66, v17
    v_add_f32 v22, 1.0, v22
    v_add_f32 v23, 1.0, v23
    v_add_f32 v24, 1.0, v24
    v_add_f32 v25, 1.0, v25
    v_rcp_f32 v22, v22
    v_rcp_f32 v23, v23
    v_rcp_f32 v24, v24
    v_rcp_f32 v25, v25
    v_mul_f32 v18, v18, v22
    v_mul_f32 v19, v19, v23
    v_mul_f32 v20, v20, v24
    v_mul_f32 v21, v21, v25
    v_cvt_pk_bf16_f32 v16, v18, v19
    v_cvt_pk_bf16_f32 v17, v20, v21
    v_lshlrev_b32 v18, 16, v16
    v_and_b32 v19, s66, v16
    v_lshlrev_b32 v20, 16, v17
    v_and_b32 v21, s66, v17
    v_mul_f32 v18, v18, v26
    v_mul_f32 v19, v19, v27
    v_mul_f32 v20, v20, v28
    v_mul_f32 v21, v21, v29
    v_cvt_pk_bf16_f32 v30, v18, v19
    v_cvt_pk_bf16_f32 v31, v20, v21
    ds_write_b64 v5, v[30:31] offset:16448
    v_cvt_pk_bf16_f32 v32, v196, v197
    v_cvt_pk_bf16_f32 v33, v198, v199
    v_lshlrev_b32 v34, 16, v32
    v_and_b32 v35, s66, v32
    v_lshlrev_b32 v36, 16, v33
    v_and_b32 v37, s66, v33
    v_mul_f32 v38, s67, v34
    v_mul_f32 v39, s67, v35
    v_mul_f32 v40, s67, v36
    v_mul_f32 v41, s67, v37
    v_exp_f32 v38, v38
    v_exp_f32 v39, v39
    v_exp_f32 v40, v40
    v_exp_f32 v41, v41
    v_cvt_pk_bf16_f32 v32, v224, v225
    v_cvt_pk_bf16_f32 v33, v226, v227
    v_lshlrev_b32 v42, 16, v32
    v_and_b32 v43, s66, v32
    v_lshlrev_b32 v44, 16, v33
    v_and_b32 v45, s66, v33
    v_add_f32 v38, 1.0, v38
    v_add_f32 v39, 1.0, v39
    v_add_f32 v40, 1.0, v40
    v_add_f32 v41, 1.0, v41
    v_rcp_f32 v38, v38
    v_rcp_f32 v39, v39
    v_rcp_f32 v40, v40
    v_rcp_f32 v41, v41
    v_mul_f32 v34, v34, v38
    v_mul_f32 v35, v35, v39
    v_mul_f32 v36, v36, v40
    v_mul_f32 v37, v37, v41
    v_cvt_pk_bf16_f32 v32, v34, v35
    v_cvt_pk_bf16_f32 v33, v36, v37
    v_lshlrev_b32 v34, 16, v32
    v_and_b32 v35, s66, v32
    v_lshlrev_b32 v36, 16, v33
    v_and_b32 v37, s66, v33
    v_mul_f32 v34, v34, v42
    v_mul_f32 v35, v35, v43
    v_mul_f32 v36, v36, v44
    v_mul_f32 v37, v37, v45
    v_cvt_pk_bf16_f32 v46, v34, v35
    v_cvt_pk_bf16_f32 v47, v36, v37
    ds_write_b64 v5, v[46:47] offset:16480
    v_cvt_pk_bf16_f32 v16, v200, v201
    v_cvt_pk_bf16_f32 v17, v202, v203
    v_lshlrev_b32 v18, 16, v16
    v_and_b32 v19, s66, v16
    v_lshlrev_b32 v20, 16, v17
    v_and_b32 v21, s66, v17
    v_mul_f32 v22, s67, v18
    v_mul_f32 v23, s67, v19
    v_mul_f32 v24, s67, v20
    v_mul_f32 v25, s67, v21
    v_exp_f32 v22, v22
    v_exp_f32 v23, v23
    v_exp_f32 v24, v24
    v_exp_f32 v25, v25
    v_cvt_pk_bf16_f32 v16, v228, v229
    v_cvt_pk_bf16_f32 v17, v230, v231
    v_lshlrev_b32 v26, 16, v16
    v_and_b32 v27, s66, v16
    v_lshlrev_b32 v28, 16, v17
    v_and_b32 v29, s66, v17
    v_add_f32 v22, 1.0, v22
    v_add_f32 v23, 1.0, v23
    v_add_f32 v24, 1.0, v24
    v_add_f32 v25, 1.0, v25
    v_rcp_f32 v22, v22
    v_rcp_f32 v23, v23
    v_rcp_f32 v24, v24
    v_rcp_f32 v25, v25
    v_mul_f32 v18, v18, v22
    v_mul_f32 v19, v19, v23
    v_mul_f32 v20, v20, v24
    v_mul_f32 v21, v21, v25
    v_cvt_pk_bf16_f32 v16, v18, v19
    v_cvt_pk_bf16_f32 v17, v20, v21
    v_lshlrev_b32 v18, 16, v16
    v_and_b32 v19, s66, v16
    v_lshlrev_b32 v20, 16, v17
    v_and_b32 v21, s66, v17
    v_mul_f32 v18, v18, v26
    v_mul_f32 v19, v19, v27
    v_mul_f32 v20, v20, v28
    v_mul_f32 v21, v21, v29
    v_cvt_pk_bf16_f32 v30, v18, v19
    v_cvt_pk_bf16_f32 v31, v20, v21
    ds_write_b64 v5, v[30:31] offset:16512
    v_cvt_pk_bf16_f32 v32, v204, v205
    v_cvt_pk_bf16_f32 v33, v206, v207
    v_lshlrev_b32 v34, 16, v32
    v_and_b32 v35, s66, v32
    v_lshlrev_b32 v36, 16, v33
    v_and_b32 v37, s66, v33
    v_mul_f32 v38, s67, v34
    v_mul_f32 v39, s67, v35
    v_mul_f32 v40, s67, v36
    v_mul_f32 v41, s67, v37
    v_exp_f32 v38, v38
    v_exp_f32 v39, v39
    v_exp_f32 v40, v40
    v_exp_f32 v41, v41
    v_cvt_pk_bf16_f32 v32, v232, v233
    v_cvt_pk_bf16_f32 v33, v234, v235
    v_lshlrev_b32 v42, 16, v32
    v_and_b32 v43, s66, v32
    v_lshlrev_b32 v44, 16, v33
    v_and_b32 v45, s66, v33
    v_add_f32 v38, 1.0, v38
    v_add_f32 v39, 1.0, v39
    v_add_f32 v40, 1.0, v40
    v_add_f32 v41, 1.0, v41
    v_rcp_f32 v38, v38
    v_rcp_f32 v39, v39
    v_rcp_f32 v40, v40
    v_rcp_f32 v41, v41
    v_mul_f32 v34, v34, v38
    v_mul_f32 v35, v35, v39
    v_mul_f32 v36, v36, v40
    v_mul_f32 v37, v37, v41
    v_cvt_pk_bf16_f32 v32, v34, v35
    v_cvt_pk_bf16_f32 v33, v36, v37
    v_lshlrev_b32 v34, 16, v32
    v_and_b32 v35, s66, v32
    v_lshlrev_b32 v36, 16, v33
    v_and_b32 v37, s66, v33
    v_mul_f32 v34, v34, v42
    v_mul_f32 v35, v35, v43
    v_mul_f32 v36, v36, v44
    v_mul_f32 v37, v37, v45
    v_cvt_pk_bf16_f32 v46, v34, v35
    v_cvt_pk_bf16_f32 v47, v36, v37
    ds_write_b64 v5, v[46:47] offset:16544
    v_cvt_pk_bf16_f32 v16, v208, v209
    v_cvt_pk_bf16_f32 v17, v210, v211
    v_lshlrev_b32 v18, 16, v16
    v_and_b32 v19, s66, v16
    v_lshlrev_b32 v20, 16, v17
    v_and_b32 v21, s66, v17
    v_mul_f32 v22, s67, v18
    v_mul_f32 v23, s67, v19
    v_mul_f32 v24, s67, v20
    v_mul_f32 v25, s67, v21
    v_exp_f32 v22, v22
    v_exp_f32 v23, v23
    v_exp_f32 v24, v24
    v_exp_f32 v25, v25
    v_cvt_pk_bf16_f32 v16, v236, v237
    v_cvt_pk_bf16_f32 v17, v238, v239
    v_lshlrev_b32 v26, 16, v16
    v_and_b32 v27, s66, v16
    v_lshlrev_b32 v28, 16, v17
    v_and_b32 v29, s66, v17
    v_add_f32 v22, 1.0, v22
    v_add_f32 v23, 1.0, v23
    v_add_f32 v24, 1.0, v24
    v_add_f32 v25, 1.0, v25
    v_rcp_f32 v22, v22
    v_rcp_f32 v23, v23
    v_rcp_f32 v24, v24
    v_rcp_f32 v25, v25
    v_mul_f32 v18, v18, v22
    v_mul_f32 v19, v19, v23
    v_mul_f32 v20, v20, v24
    v_mul_f32 v21, v21, v25
    v_cvt_pk_bf16_f32 v16, v18, v19
    v_cvt_pk_bf16_f32 v17, v20, v21
    v_lshlrev_b32 v18, 16, v16
    v_and_b32 v19, s66, v16
    v_lshlrev_b32 v20, 16, v17
    v_and_b32 v21, s66, v17
    v_mul_f32 v18, v18, v26
    v_mul_f32 v19, v19, v27
    v_mul_f32 v20, v20, v28
    v_mul_f32 v21, v21, v29
    v_cvt_pk_bf16_f32 v30, v18, v19
    v_cvt_pk_bf16_f32 v31, v20, v21
    ds_write_b64 v5, v[30:31] offset:16576
    s_waitcnt lgkmcnt(0)
    ds_read_b128 v[112:115], v108 offset:16384
    ds_read_b128 v[116:119], v109 offset:16384
    ds_read_b128 v[120:123], v110 offset:16384
    s_mov_b32 exec_hi, 0
    ds_read_b128 v[124:127], v111 offset:16384
    s_mov_b32 exec_hi, -1
    s_waitcnt lgkmcnt(3)
    buffer_store_dwordx4 v[112:115], v104, s[20:23], s76 offen sc1
    s_waitcnt lgkmcnt(2)
    buffer_store_dwordx4 v[116:119], v105, s[20:23], s76 offen sc1
    s_waitcnt lgkmcnt(1)
    buffer_store_dwordx4 v[120:123], v106, s[20:23], s76 offen sc1
    s_waitcnt lgkmcnt(0)
    s_mov_b32 exec_hi, 0
    buffer_store_dwordx4 v[124:127], v107, s[20:23], s76 offen sc1
    s_mov_b32 exec_hi, -1
    s_waitcnt vmcnt(0)
    s_barrier
    v_mov_b32 v5, s83
    s_lshl_b32 s64, s2, 2
    s_add_u32 s64, s64, 8192
    v_lshlrev_b32 v6, 10, v0
    v_add_u32 v6, s64, v6
    v_cmp_gt_u32 vcc, 8, v0
    s_nop 0
    s_and_saveexec_b64 s[64:65], vcc
    s_cbranch_execz MK_11
    buffer_store_dword v5, v6, s[4:7], 0 offen sc1
MK_11:
    s_mov_b64 exec, s[64:65]
    s_and_b32 s64, s2, 7
    s_lshr_b32 s65, s2, 3
    s_lshl_b32 s70, s64, 2
    s_lshr_b32 s66, s65, 3
    s_add_u32 s70, s70, s66
    s_and_b32 s71, s65, 7
    s_lshl_b32 s72, s70, 6
    s_lshl_b32 s73, s71, 7
    s_lshl_b32 s75, s68, 11
    s_and_b32 s77, s68, 1
    s_lshr_b32 s78, s68, 1
    v_lshrrev_b32 v5, 3, v4
    v_and_b32 v6, 7, v4
    s_lshl_b32 s74, s68, 4
    s_add_u32 s66, s72, s74
    v_add_u32 v7, s66, v5
    v_mul_u32_u24 v8, 3584, v7
    v_xor_b32 v9, v6, v2
    v_lshl_add_u32 v10, v9, 4, v8
    v_xor_b32 v9, 4, v9
    v_lshl_add_u32 v11, v9, 4, v8
    v_add_u32 v11, 28672, v11
    v_lshlrev_b32 v7, 10, v7
    v_lshl_add_u32 v7, v6, 4, v7
    v_add_u32 v14, s73, v7
    v_add_u32 v7, s74, v5
    v_lshlrev_b32 v7, 10, v7
    v_add_u32 v7, s73, v7
    v_and_b32 v8, 1, v2
    v_lshlrev_b32 v8, 1, v8
    v_xor_b32 v8, v6, v8
    v_lshl_add_u32 v12, v8, 4, v7
    v_xor_b32 v8, 4, v8
    v_lshl_add_u32 v13, v8, 4, v7
    v_add_u32 v13, 8192, v13
    s_lshl_b32 s66, s71, 6
    s_add_u32 s66, s66, s74
    v_add_u32 v7, s66, v5
    v_lshlrev_b32 v7, 12, v7
    v_lshl_add_u32 v7, v6, 4, v7
    s_lshl_b32 s66, s72, 1
    v_add_u32 v15, s66, v7
    s_lshl_b32 s66, s77, 12
    v_lshrrev_b32 v7, 1, v1
    v_xor_b32 v8, v2, v7
    v_lshlrev_b32 v9, 7, v1
    v_add_u32 v9, s66, v9
    v_lshl_add_u32 v16, v8, 4, v9
    v_xor_b32 v8, 4, v8
    v_lshl_add_u32 v17, v8, 4, v9
    v_lshrrev_b32 v7, 2, v1
    v_lshl_add_u32 v8, v2, 3, v7
    v_lshlrev_b32 v8, 7, v8
    v_and_b32 v9, 1, v0
    v_lshl_add_u32 v8, v9, 3, v8
    v_bfe_u32 v9, v1, 3, 1
    v_lshlrev_b32 v9, 1, v9
    v_and_b32 v7, 1, v2
    v_lshl_add_u32 v9, v7, 2, v9
    v_bfe_u32 v7, v0, 1, 1
    v_xor_b32 v9, v9, v7
    s_lshl_b32 s66, s78, 2
    v_xor_b32 v9, s66, v9
    v_xor_b32 v7, 0, v9
    v_lshl_add_u32 v18, v7, 4, v8
    v_xor_b32 v7, 2, v9
    v_lshl_add_u32 v19, v7, 4, v8
    s_add_u32 s76, s75, 65536
    s_mov_b32 s66, 0
    s_add_u32 m0, s75, 8192
    s_nop 0
    buffer_load_dwordx4 v12, s[36:39], s66 offen lds
    s_mov_b32 s66, 0
    s_add_u32 m0, s75, 9216
    s_nop 0
    buffer_load_dwordx4 v13, s[36:39], s66 offen lds
    s_mov_b32 s66, 65536
    s_add_u32 m0, s75, 24576
    s_nop 0
    buffer_load_dwordx4 v12, s[36:39], s66 offen lds
    s_mov_b32 s66, 65536
    s_add_u32 m0, s75, 25600
    s_nop 0
    buffer_load_dwordx4 v13, s[36:39], s66 offen lds
    s_mov_b32 s66, 131072
    s_add_u32 m0, s75, 40960
    s_nop 0
    buffer_load_dwordx4 v12, s[36:39], s66 offen lds
    s_mov_b32 s66, 131072
    s_add_u32 m0, s75, 41984
    s_nop 0
    buffer_load_dwordx4 v13, s[36:39], s66 offen lds
    s_mov_b32 s66, 196608
    s_add_u32 m0, s75, 57344
    s_nop 0
    buffer_load_dwordx4 v12, s[36:39], s66 offen lds
    s_mov_b32 s66, 196608
    s_add_u32 m0, s75, 58368
    s_nop 0
    buffer_load_dwordx4 v13, s[36:39], s66 offen lds
    s_mov_b32 s66, 0
    s_add_u32 m0, s76, 0
    s_nop 0
    buffer_load_dwordx4 v14, s[8:11], s66 offen lds
    s_mov_b32 s66, 8192
    s_add_u32 m0, s76, 1024
    s_nop 0
    buffer_load_dwordx4 v14, s[8:11], s66 offen lds
    s_mov_b32 s66, 0
    s_add_u32 m0, s76, 8192
    s_nop 0
    buffer_load_dwordx4 v14, s[12:15], s66 offen sc1 lds
    s_mov_b32 s66, 8192
    s_add_u32 m0, s76, 9216
    s_nop 0
    buffer_load_dwordx4 v14, s[12:15], s66 offen sc1 lds
    s_lshl_b32 s66, s78, 6
    s_add_u32 s66, s66, s73
    v_lshlrev_b32 v7, 3, v2
    v_add_u32 v7, s66, v7
    buffer_load_dwordx2 v[24:25], v7, s[44:47], 0 offen offset:0
    buffer_load_dwordx2 v[26:27], v7, s[44:47], 0 offen offset:32
    s_lshr_b32 s64, s70, 1
    s_and_b32 s65, s64, 7
    s_lshl_b32 s65, s65, 3
    s_lshr_b32 s64, s64, 3
    s_add_u32 s64, s64, s65
    s_lshl_b32 s64, s64, 2
    s_and_b32 s65, s2, 7
    s_lshl_b32 s65, s65, 10
    s_add_u32 s64, s64, s65
    s_add_u32 s64, s64, 8192
    v_bfe_u32 v212, v4, 2, 2
    v_lshlrev_b32 v212, 8, v212
    v_and_b32 v210, 3, v4
    v_lshl_add_u32 v210, v210, 3, v212
    v_add_u32 v210, s64, v210
    s_sleep 16
    s_cmp_lg_u32 s68, 0
    s_cbranch_scc1 PI_12
    buffer_load_dword v211, v210, s[4:7], 0 offen sc1
PI_12:
    s_cmp_lg_u32 s68, 0
    s_cbranch_scc1 POLLE_14
    s_waitcnt vmcnt(0)
    s_mov_b32 s66, 0
POLL_13:
    v_cmp_ne_u32 vcc, s83, v211
    s_add_u32 s66, s66, 1
    s_nop 1
    s_cmp_eq_u64 vcc, 0
    s_cbranch_scc1 POLLE_14
    s_cmp_gt_u32 s66, 0x40000
    s_cbranch_scc1 POLLE_14
    s_sleep 12
    buffer_load_dword v211, v210, s[4:7], 0 offen sc1
    s_waitcnt vmcnt(0)
    s_branch POLL_13
POLLE_14:
    s_barrier
    s_movk_i32 s66, 0
    s_add_u32 m0, s75, 0
    s_nop 0
    buffer_load_dwordx4 v10, s[20:23], s66 offen sc1 lds
    s_movk_i32 s66, 0
    s_add_u32 m0, s75, 1024
    s_nop 0
    buffer_load_dwordx4 v11, s[20:23], s66 offen sc1 lds
    s_movk_i32 s66, 128
    s_add_u32 m0, s75, 16384
    s_nop 0
    buffer_load_dwordx4 v10, s[20:23], s66 offen sc1 lds
    s_movk_i32 s66, 128
    s_add_u32 m0, s75, 17408
    s_nop 0
    buffer_load_dwordx4 v11, s[20:23], s66 offen sc1 lds
    s_movk_i32 s66, 256
    s_add_u32 m0, s75, 32768
    s_nop 0
    buffer_load_dwordx4 v10, s[20:23], s66 offen sc1 lds
    s_movk_i32 s66, 256
    s_add_u32 m0, s75, 33792
    s_nop 0
    buffer_load_dwordx4 v11, s[20:23], s66 offen sc1 lds
    s_movk_i32 s66, 384
    s_add_u32 m0, s75, 49152
    s_nop 0
    buffer_load_dwordx4 v10, s[20:23], s66 offen sc1 lds
    s_movk_i32 s66, 384
    s_add_u32 m0, s75, 50176
    s_nop 0
    buffer_load_dwordx4 v11, s[20:23], s66 offen sc1 lds
    v_mov_b32 v64, 0
    v_mov_b32 v65, 0
    v_mov_b32 v66, 0
    v_mov_b32 v67, 0
    v_mov_b32 v68, 0
    v_mov_b32 v69, 0
    v_mov_b32 v70, 0
    v_mov_b32 v71, 0
    v_mov_b32 v72, 0
    v_mov_b32 v73, 0
    v_mov_b32 v74, 0
    v_mov_b32 v75, 0
    v_mov_b32 v76, 0
    v_mov_b32 v77, 0
    v_mov_b32 v78, 0
    v_mov_b32 v79, 0
    s_waitcnt vmcnt(6)
    s_barrier
    ds_read_b128 v[96:99], v16 offset:0
    ds_read_b64_tr_b16 v[112:113], v18 offset:8192
    ds_read_b64_tr_b16 v[114:115], v18 offset:8704
    ds_read_b128 v[100:103], v16 offset:2048
    ds_read_b64_tr_b16 v[116:117], v19 offset:8192
    ds_read_b64_tr_b16 v[118:119], v19 offset:8704
    ds_read_b128 v[104:107], v17 offset:0
    ds_read_b64_tr_b16 v[120:121], v18 offset:12288
    ds_read_b64_tr_b16 v[122:123], v18 offset:12800
    ds_read_b128 v[108:111], v17 offset:2048
    ds_read_b64_tr_b16 v[124:125], v19 offset:12288
    ds_read_b64_tr_b16 v[126:127], v19 offset:12800
    s_waitcnt vmcnt(4)
    s_waitcnt lgkmcnt(0)
    s_barrier
    v_mfma_f32_16x16x32_bf16 v[64:67], v[112:115], v[96:99], v[64:67]
    ds_read_b128 v[128:131], v16 offset:16384
    ds_read_b64_tr_b16 v[144:145], v18 offset:24576
    v_mfma_f32_16x16x32_bf16 v[68:71], v[112:115], v[100:103], v[68:71]
    ds_read_b64_tr_b16 v[146:147], v18 offset:25088
    ds_read_b128 v[132:135], v16 offset:18432
    s_movk_i32 s66, 512
    s_add_u32 m0, s75, 0
    s_nop 0
    buffer_load_dwordx4 v10, s[20:23], s66 offen sc1 lds
    v_mfma_f32_16x16x32_bf16 v[72:75], v[116:119], v[96:99], v[72:75]
    ds_read_b64_tr_b16 v[148:149], v19 offset:24576
    ds_read_b64_tr_b16 v[150:151], v19 offset:25088
    v_mfma_f32_16x16x32_bf16 v[76:79], v[116:119], v[100:103], v[76:79]
    ds_read_b128 v[136:139], v17 offset:16384
    ds_read_b64_tr_b16 v[152:153], v18 offset:28672
    s_mov_b32 s66, 262144
    s_add_u32 m0, s75, 8192
    s_nop 0
    buffer_load_dwordx4 v12, s[36:39], s66 offen lds
    v_mfma_f32_16x16x32_bf16 v[64:67], v[120:123], v[104:107], v[64:67]
    ds_read_b64_tr_b16 v[154:155], v18 offset:29184
    v_mfma_f32_16x16x32_bf16 v[68:71], v[120:123], v[108:111], v[68:71]
    ds_read_b128 v[140:143], v17 offset:18432
    s_movk_i32 s66, 512
    s_add_u32 m0, s75, 1024
    s_nop 0
    buffer_load_dwordx4 v11, s[20:23], s66 offen sc1 lds
    v_mfma_f32_16x16x32_bf16 v[72:75], v[124:127], v[104:107], v[72:75]
    ds_read_b64_tr_b16 v[156:157], v19 offset:28672
    v_mfma_f32_16x16x32_bf16 v[76:79], v[124:127], v[108:111], v[76:79]
    ds_read_b64_tr_b16 v[158:159], v19 offset:29184
    s_mov_b32 s66, 262144
    s_add_u32 m0, s75, 9216
    s_nop 0
    buffer_load_dwordx4 v13, s[36:39], s66 offen lds
    s_waitcnt vmcnt(6)
    s_waitcnt lgkmcnt(0)
    s_barrier
    v_mfma_f32_16x16x32_bf16 v[64:67], v[144:147], v[128:131], v[64:67]
    ds_read_b128 v[96:99], v16 offset:32768
    ds_read_b64_tr_b16 v[112:113], v18 offset:40960
    v_mfma_f32_16x16x32_bf16 v[68:71], v[144:147], v[132:135], v[68:71]
    ds_read_b64_tr_b16 v[114:115], v18 offset:41472
    ds_read_b128 v[100:103], v16 offset:34816
    s_movk_i32 s66, 640
    s_add_u32 m0, s75, 16384
    s_nop 0
    buffer_load_dwordx4 v10, s[20:23], s66 offen sc1 lds
    v_mfma_f32_16x16x32_bf16 v[72:75], v[148:151], v[128:131], v[72:75]
    ds_read_b64_tr_b16 v[116:117], v19 offset:40960
    ds_read_b64_tr_b16 v[118:119], v19 offset:41472
    v_mfma_f32_16x16x32_bf16 v[76:79], v[148:151], v[132:135], v[76:79]
    ds_read_b128 v[104:107], v17 offset:32768
    ds_read_b64_tr_b16 v[120:121], v18 offset:45056
    s_mov_b32 s66, 327680
    s_add_u32 m0, s75, 24576
    s_nop 0
    buffer_load_dwordx4 v12, s[36:39], s66 offen lds
    v_mfma_f32_16x16x32_bf16 v[64:67], v[152:155], v[136:139], v[64:67]
    ds_read_b64_tr_b16 v[122:123], v18 offset:45568
    v_mfma_f32_16x16x32_bf16 v[68:71], v[152:155], v[140:143], v[68:71]
    ds_read_b128 v[108:111], v17 offset:34816
    s_movk_i32 s66, 640
    s_add_u32 m0, s75, 17408
    s_nop 0
    buffer_load_dwordx4 v11, s[20:23], s66 offen sc1 lds
    v_mfma_f32_16x16x32_bf16 v[72:75], v[156:159], v[136:139], v[72:75]
    ds_read_b64_tr_b16 v[124:125], v19 offset:45056
    v_mfma_f32_16x16x32_bf16 v[76:79], v[156:159], v[140:143], v[76:79]
    ds_read_b64_tr_b16 v[126:127], v19 offset:45568
    s_mov_b32 s66, 327680
    s_add_u32 m0, s75, 25600
    s_nop 0
    buffer_load_dwordx4 v13, s[36:39], s66 offen lds
    s_waitcnt vmcnt(8)
    s_waitcnt lgkmcnt(0)
    s_barrier
    v_mfma_f32_16x16x32_bf16 v[64:67], v[112:115], v[96:99], v[64:67]
    ds_read_b128 v[128:131], v16 offset:49152
    ds_read_b64_tr_b16 v[144:145], v18 offset:57344
    v_mfma_f32_16x16x32_bf16 v[68:71], v[112:115], v[100:103], v[68:71]
    ds_read_b64_tr_b16 v[146:147], v18 offset:57856
    ds_read_b128 v[132:135], v16 offset:51200
    s_movk_i32 s66, 768
    s_add_u32 m0, s75, 32768
    s_nop 0
    buffer_load_dwordx4 v10, s[20:23], s66 offen sc1 lds
    v_mfma_f32_16x16x32_bf16 v[72:75], v[116:119], v[96:99], v[72:75]
    ds_read_b64_tr_b16 v[148:149], v19 offset:57344
    ds_read_b64_tr_b16 v[150:151], v19 offset:57856
    v_mfma_f32_16x16x32_bf16 v[76:79], v[116:119], v[100:103], v[76:79]
    ds_read_b128 v[136:139], v17 offset:49152
    ds_read_b64_tr_b16 v[152:153], v18 offset:61440
    s_mov_b32 s66, 393216
    s_add_u32 m0, s75, 40960
    s_nop 0
    buffer_load_dwordx4 v12, s[36:39], s66 offen lds
    v_mfma_f32_16x16x32_bf16 v[64:67], v[120:123], v[104:107], v[64:67]
    ds_read_b64_tr_b16 v[154:155], v18 offset:61952
    v_mfma_f32_16x16x32_bf16 v[68:71], v[120:123], v[108:111], v[68:71]
    ds_read_b128 v[140:143], v17 offset:51200
    s_movk_i32 s66, 768
    s_add_u32 m0, s75, 33792
    s_nop 0
    buffer_load_dwordx4 v11, s[20:23], s66 offen sc1 lds
    v_mfma_f32_16x16x32_bf16 v[72:75], v[124:127], v[104:107], v[72:75]
    ds_read_b64_tr_b16 v[156:157], v19 offset:61440
    v_mfma_f32_16x16x32_bf16 v[76:79], v[124:127], v[108:111], v[76:79]
    ds_read_b64_tr_b16 v[158:159], v19 offset:61952
    s_mov_b32 s66, 393216
    s_add_u32 m0, s75, 41984
    s_nop 0
    buffer_load_dwordx4 v13, s[36:39], s66 offen lds
    s_waitcnt vmcnt(8)
    s_waitcnt lgkmcnt(0)
    s_barrier
    v_mfma_f32_16x16x32_bf16 v[64:67], v[144:147], v[128:131], v[64:67]
    ds_read_b128 v[96:99], v16 offset:0
    ds_read_b64_tr_b16 v[112:113], v18 offset:8192
    v_mfma_f32_16x16x32_bf16 v[68:71], v[144:147], v[132:135], v[68:71]
    ds_read_b64_tr_b16 v[114:115], v18 offset:8704
    ds_read_b128 v[100:103], v16 offset:2048
    s_movk_i32 s66, 896
    s_add_u32 m0, s75, 49152
    s_nop 0
    buffer_load_dwordx4 v10, s[20:23], s66 offen sc1 lds
    v_mfma_f32_16x16x32_bf16 v[72:75], v[148:151], v[128:131], v[72:75]
    ds_read_b64_tr_b16 v[116:117], v19 offset:8192
    ds_read_b64_tr_b16 v[118:119], v19 offset:8704
    v_mfma_f32_16x16x32_bf16 v[76:79], v[148:151], v[132:135], v[76:79]
    ds_read_b128 v[104:107], v17 offset:0
    ds_read_b64_tr_b16 v[120:121], v18 offset:12288
    s_mov_b32 s66, 458752
    s_add_u32 m0, s75, 57344
    s_nop 0
    buffer_load_dwordx4 v12, s[36:39], s66 offen lds
    v_mfma_f32_16x16x32_bf16 v[64:67], v[152:155], v[136:139], v[64:67]
    ds_read_b64_tr_b16 v[122:123], v18 offset:12800
    v_mfma_f32_16x16x32_bf16 v[68:71], v[152:155], v[140:143], v[68:71]
    ds_read_b128 v[108:111], v17 offset:2048
    s_movk_i32 s66, 896
    s_add_u32 m0, s75, 50176
    s_nop 0
    buffer_load_dwordx4 v11, s[20:23], s66 offen sc1 lds
    v_mfma_f32_16x16x32_bf16 v[72:75], v[156:159], v[136:139], v[72:75]
    ds_read_b64_tr_b16 v[124:125], v19 offset:12288
    v_mfma_f32_16x16x32_bf16 v[76:79], v[156:159], v[140:143], v[76:79]
    ds_read_b64_tr_b16 v[126:127], v19 offset:12800
    s_mov_b32 s66, 458752
    s_add_u32 m0, s75, 58368
    s_nop 0
    buffer_load_dwordx4 v13, s[36:39], s66 offen lds
    s_waitcnt vmcnt(8)
    s_waitcnt lgkmcnt(0)
    s_barrier
    v_mfma_f32_16x16x32_bf16 v[64:67], v[112:115], v[96:99], v[64:67]
    ds_read_b128 v[128:131], v16 offset:16384
    ds_read_b64_tr_b16 v[144:145], v18 offset:24576
    v_mfma_f32_16x16x32_bf16 v[68:71], v[112:115], v[100:103], v[68:71]
    ds_read_b64_tr_b16 v[146:147], v18 offset:25088
    ds_read_b128 v[132:135], v16 offset:18432
    s_movk_i32 s66, 1024
    s_add_u32 m0, s75, 0
    s_nop 0
    buffer_load_dwordx4 v10, s[20:23], s66 offen sc1 lds
    v_mfma_f32_16x16x32_bf16 v[72:75], v[116:119], v[96:99], v[72:75]
    ds_read_b64_tr_b16 v[148:149], v19 offset:24576
    ds_read_b64_tr_b16 v[150:151], v19 offset:25088
    v_mfma_f32_16x16x32_bf16 v[76:79], v[116:119], v[100:103], v[76:79]
    ds_read_b128 v[136:139], v17 offset:16384
    ds_read_b64_tr_b16 v[152:153], v18 offset:28672
    s_mov_b32 s66, 524288
    s_add_u32 m0, s75, 8192
    s_nop 0
    buffer_load_dwordx4 v12, s[36:39], s66 offen lds
    v_mfma_f32_16x16x32_bf16 v[64:67], v[120:123], v[104:107], v[64:67]
    ds_read_b64_tr_b16 v[154:155], v18 offset:29184
    v_mfma_f32_16x16x32_bf16 v[68:71], v[120:123], v[108:111], v[68:71]
    ds_read_b128 v[140:143], v17 offset:18432
    s_movk_i32 s66, 1024
    s_add_u32 m0, s75, 1024
    s_nop 0
    buffer_load_dwordx4 v11, s[20:23], s66 offen sc1 lds
    v_mfma_f32_16x16x32_bf16 v[72:75], v[124:127], v[104:107], v[72:75]
    ds_read_b64_tr_b16 v[156:157], v19 offset:28672
    v_mfma_f32_16x16x32_bf16 v[76:79], v[124:127], v[108:111], v[76:79]
    ds_read_b64_tr_b16 v[158:159], v19 offset:29184
    s_mov_b32 s66, 524288
    s_add_u32 m0, s75, 9216
    s_nop 0
    buffer_load_dwordx4 v13, s[36:39], s66 offen lds
    s_waitcnt vmcnt(8)
    s_waitcnt lgkmcnt(0)
    s_barrier
    v_mfma_f32_16x16x32_bf16 v[64:67], v[144:147], v[128:131], v[64:67]
    ds_read_b128 v[96:99], v16 offset:32768
    ds_read_b64_tr_b16 v[112:113], v18 offset:40960
    v_mfma_f32_16x16x32_bf16 v[68:71], v[144:147], v[132:135], v[68:71]
    ds_read_b64_tr_b16 v[114:115], v18 offset:41472
    ds_read_b128 v[100:103], v16 offset:34816
    s_movk_i32 s66, 1152
    s_add_u32 m0, s75, 16384
    s_nop 0
    buffer_load_dwordx4 v10, s[20:23], s66 offen sc1 lds
    v_mfma_f32_16x16x32_bf16 v[72:75], v[148:151], v[128:131], v[72:75]
    ds_read_b64_tr_b16 v[116:117], v19 offset:40960
    ds_read_b64_tr_b16 v[118:119], v19 offset:41472
    v_mfma_f32_16x16x32_bf16 v[76:79], v[148:151], v[132:135], v[76:79]
    ds_read_b128 v[104:107], v17 offset:32768
    ds_read_b64_tr_b16 v[120:121], v18 offset:45056
    s_mov_b32 s66, 589824
    s_add_u32 m0, s75, 24576
    s_nop 0
    buffer_load_dwordx4 v12, s[36:39], s66 offen lds
    v_mfma_f32_16x16x32_bf16 v[64:67], v[152:155], v[136:139], v[64:67]
    ds_read_b64_tr_b16 v[122:123], v18 offset:45568
    v_mfma_f32_16x16x32_bf16 v[68:71], v[152:155], v[140:143], v[68:71]
    ds_read_b128 v[108:111], v17 offset:34816
    s_movk_i32 s66, 1152
    s_add_u32 m0, s75, 17408
    s_nop 0
    buffer_load_dwordx4 v11, s[20:23], s66 offen sc1 lds
    v_mfma_f32_16x16x32_bf16 v[72:75], v[156:159], v[136:139], v[72:75]
    ds_read_b64_tr_b16 v[124:125], v19 offset:45056
    v_mfma_f32_16x16x32_bf16 v[76:79], v[156:159], v[140:143], v[76:79]
    ds_read_b64_tr_b16 v[126:127], v19 offset:45568
    s_mov_b32 s66, 589824
    s_add_u32 m0, s75, 25600
    s_nop 0
    buffer_load_dwordx4 v13, s[36:39], s66 offen lds
    s_waitcnt vmcnt(8)
    s_waitcnt lgkmcnt(0)
    s_barrier
    v_mfma_f32_16x16x32_bf16 v[64:67], v[112:115], v[96:99], v[64:67]
    ds_read_b128 v[128:131], v16 offset:49152
    ds_read_b64_tr_b16 v[144:145], v18 offset:57344
    v_mfma_f32_16x16x32_bf16 v[68:71], v[112:115], v[100:103], v[68:71]
    ds_read_b64_tr_b16 v[146:147], v18 offset:57856
    ds_read_b128 v[132:135], v16 offset:51200
    s_movk_i32 s66, 1280
    s_add_u32 m0, s75, 32768
    s_nop 0
    buffer_load_dwordx4 v10, s[20:23], s66 offen sc1 lds
    v_mfma_f32_16x16x32_bf16 v[72:75], v[116:119], v[96:99], v[72:75]
    ds_read_b64_tr_b16 v[148:149], v19 offset:57344
    ds_read_b64_tr_b16 v[150:151], v19 offset:57856
    v_mfma_f32_16x16x32_bf16 v[76:79], v[116:119], v[100:103], v[76:79]
    ds_read_b128 v[136:139], v17 offset:49152
    ds_read_b64_tr_b16 v[152:153], v18 offset:61440
    s_mov_b32 s66, 655360
    s_add_u32 m0, s75, 40960
    s_nop 0
    buffer_load_dwordx4 v12, s[36:39], s66 offen lds
    v_mfma_f32_16x16x32_bf16 v[64:67], v[120:123], v[104:107], v[64:67]
    ds_read_b64_tr_b16 v[154:155], v18 offset:61952
    v_mfma_f32_16x16x32_bf16 v[68:71], v[120:123], v[108:111], v[68:71]
    ds_read_b128 v[140:143], v17 offset:51200
    s_movk_i32 s66, 1280
    s_add_u32 m0, s75, 33792
    s_nop 0
    buffer_load_dwordx4 v11, s[20:23], s66 offen sc1 lds
    v_mfma_f32_16x16x32_bf16 v[72:75], v[124:127], v[104:107], v[72:75]
    ds_read_b64_tr_b16 v[156:157], v19 offset:61440
    v_mfma_f32_16x16x32_bf16 v[76:79], v[124:127], v[108:111], v[76:79]
    ds_read_b64_tr_b16 v[158:159], v19 offset:61952
    s_mov_b32 s66, 655360
    s_add_u32 m0, s75, 41984
    s_nop 0
    buffer_load_dwordx4 v13, s[36:39], s66 offen lds
    s_waitcnt vmcnt(8)
    s_waitcnt lgkmcnt(0)
    s_barrier
    v_mfma_f32_16x16x32_bf16 v[64:67], v[144:147], v[128:131], v[64:67]
    ds_read_b128 v[96:99], v16 offset:0
    ds_read_b64_tr_b16 v[112:113], v18 offset:8192
    v_mfma_f32_16x16x32_bf16 v[68:71], v[144:147], v[132:135], v[68:71]
    ds_read_b64_tr_b16 v[114:115], v18 offset:8704
    ds_read_b128 v[100:103], v16 offset:2048
    s_movk_i32 s66, 1408
    s_add_u32 m0, s75, 49152
    s_nop 0
    buffer_load_dwordx4 v10, s[20:23], s66 offen sc1 lds
    v_mfma_f32_16x16x32_bf16 v[72:75], v[148:151], v[128:131], v[72:75]
    ds_read_b64_tr_b16 v[116:117], v19 offset:8192
    ds_read_b64_tr_b16 v[118:119], v19 offset:8704
    v_mfma_f32_16x16x32_bf16 v[76:79], v[148:151], v[132:135], v[76:79]
    ds_read_b128 v[104:107], v17 offset:0
    ds_read_b64_tr_b16 v[120:121], v18 offset:12288
    s_mov_b32 s66, 720896
    s_add_u32 m0, s75, 57344
    s_nop 0
    buffer_load_dwordx4 v12, s[36:39], s66 offen lds
    v_mfma_f32_16x16x32_bf16 v[64:67], v[152:155], v[136:139], v[64:67]
    ds_read_b64_tr_b16 v[122:123], v18 offset:12800
    v_mfma_f32_16x16x32_bf16 v[68:71], v[152:155], v[140:143], v[68:71]
    ds_read_b128 v[108:111], v17 offset:2048
    s_movk_i32 s66, 1408
    s_add_u32 m0, s75, 50176
    s_nop 0
    buffer_load_dwordx4 v11, s[20:23], s66 offen sc1 lds
    v_mfma_f32_16x16x32_bf16 v[72:75], v[156:159], v[136:139], v[72:75]
    ds_read_b64_tr_b16 v[124:125], v19 offset:12288
    v_mfma_f32_16x16x32_bf16 v[76:79], v[156:159], v[140:143], v[76:79]
    ds_read_b64_tr_b16 v[126:127], v19 offset:12800
    s_mov_b32 s66, 720896
    s_add_u32 m0, s75, 58368
    s_nop 0
    buffer_load_dwordx4 v13, s[36:39], s66 offen lds
    s_waitcnt vmcnt(8)
    s_waitcnt lgkmcnt(0)
    s_barrier
    v_mfma_f32_16x16x32_bf16 v[64:67], v[112:115], v[96:99], v[64:67]
    ds_read_b128 v[128:131], v16 offset:16384
    ds_read_b64_tr_b16 v[144:145], v18 offset:24576
    v_mfma_f32_16x16x32_bf16 v[68:71], v[112:115], v[100:103], v[68:71]
    ds_read_b64_tr_b16 v[146:147], v18 offset:25088
    ds_read_b128 v[132:135], v16 offset:18432
    s_movk_i32 s66, 1536
    s_add_u32 m0, s75, 0
    s_nop 0
    buffer_load_dwordx4 v10, s[20:23], s66 offen sc1 lds
    v_mfma_f32_16x16x32_bf16 v[72:75], v[116:119], v[96:99], v[72:75]
    ds_read_b64_tr_b16 v[148:149], v19 offset:24576
    ds_read_b64_tr_b16 v[150:151], v19 offset:25088
    v_mfma_f32_16x16x32_bf16 v[76:79], v[116:119], v[100:103], v[76:79]
    ds_read_b128 v[136:139], v17 offset:16384
    ds_read_b64_tr_b16 v[152:153], v18 offset:28672
    s_mov_b32 s66, 786432
    s_add_u32 m0, s75, 8192
    s_nop 0
    buffer_load_dwordx4 v12, s[36:39], s66 offen lds
    v_mfma_f32_16x16x32_bf16 v[64:67], v[120:123], v[104:107], v[64:67]
    ds_read_b64_tr_b16 v[154:155], v18 offset:29184
    v_mfma_f32_16x16x32_bf16 v[68:71], v[120:123], v[108:111], v[68:71]
    ds_read_b128 v[140:143], v17 offset:18432
    s_movk_i32 s66, 1536
    s_add_u32 m0, s75, 1024
    s_nop 0
    buffer_load_dwordx4 v11, s[20:23], s66 offen sc1 lds
    v_mfma_f32_16x16x32_bf16 v[72:75], v[124:127], v[104:107], v[72:75]
    ds_read_b64_tr_b16 v[156:157], v19 offset:28672
    v_mfma_f32_16x16x32_bf16 v[76:79], v[124:127], v[108:111], v[76:79]
    ds_read_b64_tr_b16 v[158:159], v19 offset:29184
    s_mov_b32 s66, 786432
    s_add_u32 m0, s75, 9216
    s_nop 0
    buffer_load_dwordx4 v13, s[36:39], s66 offen lds
    s_waitcnt vmcnt(8)
    s_waitcnt lgkmcnt(0)
    s_barrier
    v_mfma_f32_16x16x32_bf16 v[64:67], v[144:147], v[128:131], v[64:67]
    ds_read_b128 v[96:99], v16 offset:32768
    ds_read_b64_tr_b16 v[112:113], v18 offset:40960
    v_mfma_f32_16x16x32_bf16 v[68:71], v[144:147], v[132:135], v[68:71]
    ds_read_b64_tr_b16 v[114:115], v18 offset:41472
    ds_read_b128 v[100:103], v16 offset:34816
    s_movk_i32 s66, 1664
    s_add_u32 m0, s75, 16384
    s_nop 0
    buffer_load_dwordx4 v10, s[20:23], s66 offen sc1 lds
    v_mfma_f32_16x16x32_bf16 v[72:75], v[148:151], v[128:131], v[72:75]
    ds_read_b64_tr_b16 v[116:117], v19 offset:40960
    ds_read_b64_tr_b16 v[118:119], v19 offset:41472
    v_mfma_f32_16x16x32_bf16 v[76:79], v[148:151], v[132:135], v[76:79]
    ds_read_b128 v[104:107], v17 offset:32768
    ds_read_b64_tr_b16 v[120:121], v18 offset:45056
    s_mov_b32 s66, 851968
    s_add_u32 m0, s75, 24576
    s_nop 0
    buffer_load_dwordx4 v12, s[36:39], s66 offen lds
    v_mfma_f32_16x16x32_bf16 v[64:67], v[152:155], v[136:139], v[64:67]
    ds_read_b64_tr_b16 v[122:123], v18 offset:45568
    v_mfma_f32_16x16x32_bf16 v[68:71], v[152:155], v[140:143], v[68:71]
    ds_read_b128 v[108:111], v17 offset:34816
    s_movk_i32 s66, 1664
    s_add_u32 m0, s75, 17408
    s_nop 0
    buffer_load_dwordx4 v11, s[20:23], s66 offen sc1 lds
    v_mfma_f32_16x16x32_bf16 v[72:75], v[156:159], v[136:139], v[72:75]
    ds_read_b64_tr_b16 v[124:125], v19 offset:45056
    v_mfma_f32_16x16x32_bf16 v[76:79], v[156:159], v[140:143], v[76:79]
    ds_read_b64_tr_b16 v[126:127], v19 offset:45568
    s_mov_b32 s66, 851968
    s_add_u32 m0, s75, 25600
    s_nop 0
    buffer_load_dwordx4 v13, s[36:39], s66 offen lds
    s_waitcnt vmcnt(8)
    s_waitcnt lgkmcnt(0)
    s_barrier
    v_mfma_f32_16x16x32_bf16 v[64:67], v[112:115], v[96:99], v[64:67]
    ds_read_b128 v[128:131], v16 offset:49152
    ds_read_b64_tr_b16 v[144:145], v18 offset:57344
    v_mfma_f32_16x16x32_bf16 v[68:71], v[112:115], v[100:103], v[68:71]
    ds_read_b64_tr_b16 v[146:147], v18 offset:57856
    ds_read_b128 v[132:135], v16 offset:51200
    s_movk_i32 s66, 1792
    s_add_u32 m0, s75, 32768
    s_nop 0
    buffer_load_dwordx4 v10, s[20:23], s66 offen sc1 lds
    v_mfma_f32_16x16x32_bf16 v[72:75], v[116:119], v[96:99], v[72:75]
    ds_read_b64_tr_b16 v[148:149], v19 offset:57344
    ds_read_b64_tr_b16 v[150:151], v19 offset:57856
    v_mfma_f32_16x16x32_bf16 v[76:79], v[116:119], v[100:103], v[76:79]
    ds_read_b128 v[136:139], v17 offset:49152
    ds_read_b64_tr_b16 v[152:153], v18 offset:61440
    s_mov_b32 s66, 917504
    s_add_u32 m0, s75, 40960
    s_nop 0
    buffer_load_dwordx4 v12, s[36:39], s66 offen lds
    v_mfma_f32_16x16x32_bf16 v[64:67], v[120:123], v[104:107], v[64:67]
    ds_read_b64_tr_b16 v[154:155], v18 offset:61952
    v_mfma_f32_16x16x32_bf16 v[68:71], v[120:123], v[108:111], v[68:71]
    ds_read_b128 v[140:143], v17 offset:51200
    s_movk_i32 s66, 1792
    s_add_u32 m0, s75, 33792
    s_nop 0
    buffer_load_dwordx4 v11, s[20:23], s66 offen sc1 lds
    v_mfma_f32_16x16x32_bf16 v[72:75], v[124:127], v[104:107], v[72:75]
    ds_read_b64_tr_b16 v[156:157], v19 offset:61440
    v_mfma_f32_16x16x32_bf16 v[76:79], v[124:127], v[108:111], v[76:79]
    ds_read_b64_tr_b16 v[158:159], v19 offset:61952
    s_mov_b32 s66, 917504
    s_add_u32 m0, s75, 41984
    s_nop 0
    buffer_load_dwordx4 v13, s[36:39], s66 offen lds
    s_waitcnt vmcnt(8)
    s_waitcnt lgkmcnt(0)
    s_barrier
    v_mfma_f32_16x16x32_bf16 v[64:67], v[144:147], v[128:131], v[64:67]
    ds_read_b128 v[96:99], v16 offset:0
    ds_read_b64_tr_b16 v[112:113], v18 offset:8192
    v_mfma_f32_16x16x32_bf16 v[68:71], v[144:147], v[132:135], v[68:71]
    ds_read_b64_tr_b16 v[114:115], v18 offset:8704
    ds_read_b128 v[100:103], v16 offset:2048
    s_movk_i32 s66, 1920
    s_add_u32 m0, s75, 49152
    s_nop 0
    buffer_load_dwordx4 v10, s[20:23], s66 offen sc1 lds
    v_mfma_f32_16x16x32_bf16 v[72:75], v[148:151], v[128:131], v[72:75]
    ds_read_b64_tr_b16 v[116:117], v19 offset:8192
    ds_read_b64_tr_b16 v[118:119], v19 offset:8704
    v_mfma_f32_16x16x32_bf16 v[76:79], v[148:151], v[132:135], v[76:79]
    ds_read_b128 v[104:107], v17 offset:0
    ds_read_b64_tr_b16 v[120:121], v18 offset:12288
    s_mov_b32 s66, 983040
    s_add_u32 m0, s75, 57344
    s_nop 0
    buffer_load_dwordx4 v12, s[36:39], s66 offen lds
    v_mfma_f32_16x16x32_bf16 v[64:67], v[152:155], v[136:139], v[64:67]
    ds_read_b64_tr_b16 v[122:123], v18 offset:12800
    v_mfma_f32_16x16x32_bf16 v[68:71], v[152:155], v[140:143], v[68:71]
    ds_read_b128 v[108:111], v17 offset:2048
    s_movk_i32 s66, 1920
    s_add_u32 m0, s75, 50176
    s_nop 0
    buffer_load_dwordx4 v11, s[20:23], s66 offen sc1 lds
    v_mfma_f32_16x16x32_bf16 v[72:75], v[156:159], v[136:139], v[72:75]
    ds_read_b64_tr_b16 v[124:125], v19 offset:12288
    v_mfma_f32_16x16x32_bf16 v[76:79], v[156:159], v[140:143], v[76:79]
    ds_read_b64_tr_b16 v[126:127], v19 offset:12800
    s_mov_b32 s66, 983040
    s_add_u32 m0, s75, 58368
    s_nop 0
    buffer_load_dwordx4 v13, s[36:39], s66 offen lds
    s_waitcnt vmcnt(8)
    s_waitcnt lgkmcnt(0)
    s_barrier
    v_mfma_f32_16x16x32_bf16 v[64:67], v[112:115], v[96:99], v[64:67]
    ds_read_b128 v[128:131], v16 offset:16384
    ds_read_b64_tr_b16 v[144:145], v18 offset:24576
    v_mfma_f32_16x16x32_bf16 v[68:71], v[112:115], v[100:103], v[68:71]
    ds_read_b64_tr_b16 v[146:147], v18 offset:25088
    ds_read_b128 v[132:135], v16 offset:18432
    s_movk_i32 s66, 2048
    s_add_u32 m0, s75, 0
    s_nop 0
    buffer_load_dwordx4 v10, s[20:23], s66 offen sc1 lds
    v_mfma_f32_16x16x32_bf16 v[72:75], v[116:119], v[96:99], v[72:75]
    ds_read_b64_tr_b16 v[148:149], v19 offset:24576
    ds_read_b64_tr_b16 v[150:151], v19 offset:25088
    v_mfma_f32_16x16x32_bf16 v[76:79], v[116:119], v[100:103], v[76:79]
    ds_read_b128 v[136:139], v17 offset:16384
    ds_read_b64_tr_b16 v[152:153], v18 offset:28672
    s_mov_b32 s66, 1048576
    s_add_u32 m0, s75, 8192
    s_nop 0
    buffer_load_dwordx4 v12, s[36:39], s66 offen lds
    v_mfma_f32_16x16x32_bf16 v[64:67], v[120:123], v[104:107], v[64:67]
    ds_read_b64_tr_b16 v[154:155], v18 offset:29184
    v_mfma_f32_16x16x32_bf16 v[68:71], v[120:123], v[108:111], v[68:71]
    ds_read_b128 v[140:143], v17 offset:18432
    s_movk_i32 s66, 2048
    s_add_u32 m0, s75, 1024
    s_nop 0
    buffer_load_dwordx4 v11, s[20:23], s66 offen sc1 lds
    v_mfma_f32_16x16x32_bf16 v[72:75], v[124:127], v[104:107], v[72:75]
    ds_read_b64_tr_b16 v[156:157], v19 offset:28672
    v_mfma_f32_16x16x32_bf16 v[76:79], v[124:127], v[108:111], v[76:79]
    ds_read_b64_tr_b16 v[158:159], v19 offset:29184
    s_mov_b32 s66, 1048576
    s_add_u32 m0, s75, 9216
    s_nop 0
    buffer_load_dwordx4 v13, s[36:39], s66 offen lds
    s_waitcnt vmcnt(8)
    s_waitcnt lgkmcnt(0)
    s_barrier
    v_mfma_f32_16x16x32_bf16 v[64:67], v[144:147], v[128:131], v[64:67]
    ds_read_b128 v[96:99], v16 offset:32768
    ds_read_b64_tr_b16 v[112:113], v18 offset:40960
    v_mfma_f32_16x16x32_bf16 v[68:71], v[144:147], v[132:135], v[68:71]
    ds_read_b64_tr_b16 v[114:115], v18 offset:41472
    ds_read_b128 v[100:103], v16 offset:34816
    s_movk_i32 s66, 2176
    s_add_u32 m0, s75, 16384
    s_nop 0
    buffer_load_dwordx4 v10, s[20:23], s66 offen sc1 lds
    v_mfma_f32_16x16x32_bf16 v[72:75], v[148:151], v[128:131], v[72:75]
    ds_read_b64_tr_b16 v[116:117], v19 offset:40960
    ds_read_b64_tr_b16 v[118:119], v19 offset:41472
    v_mfma_f32_16x16x32_bf16 v[76:79], v[148:151], v[132:135], v[76:79]
    ds_read_b128 v[104:107], v17 offset:32768
    ds_read_b64_tr_b16 v[120:121], v18 offset:45056
    s_mov_b32 s66, 1114112
    s_add_u32 m0, s75, 24576
    s_nop 0
    buffer_load_dwordx4 v12, s[36:39], s66 offen lds
    v_mfma_f32_16x16x32_bf16 v[64:67], v[152:155], v[136:139], v[64:67]
    ds_read_b64_tr_b16 v[122:123], v18 offset:45568
    v_mfma_f32_16x16x32_bf16 v[68:71], v[152:155], v[140:143], v[68:71]
    ds_read_b128 v[108:111], v17 offset:34816
    s_movk_i32 s66, 2176
    s_add_u32 m0, s75, 17408
    s_nop 0
    buffer_load_dwordx4 v11, s[20:23], s66 offen sc1 lds
    v_mfma_f32_16x16x32_bf16 v[72:75], v[156:159], v[136:139], v[72:75]
    ds_read_b64_tr_b16 v[124:125], v19 offset:45056
    v_mfma_f32_16x16x32_bf16 v[76:79], v[156:159], v[140:143], v[76:79]
    ds_read_b64_tr_b16 v[126:127], v19 offset:45568
    s_mov_b32 s66, 1114112
    s_add_u32 m0, s75, 25600
    s_nop 0
    buffer_load_dwordx4 v13, s[36:39], s66 offen lds
    s_waitcnt vmcnt(8)
    s_waitcnt lgkmcnt(0)
    s_barrier
    v_mfma_f32_16x16x32_bf16 v[64:67], v[112:115], v[96:99], v[64:67]
    ds_read_b128 v[128:131], v16 offset:49152
    ds_read_b64_tr_b16 v[144:145], v18 offset:57344
    v_mfma_f32_16x16x32_bf16 v[68:71], v[112:115], v[100:103], v[68:71]
    ds_read_b64_tr_b16 v[146:147], v18 offset:57856
    ds_read_b128 v[132:135], v16 offset:51200
    s_movk_i32 s66, 2304
    s_add_u32 m0, s75, 32768
    s_nop 0
    buffer_load_dwordx4 v10, s[20:23], s66 offen sc1 lds
    v_mfma_f32_16x16x32_bf16 v[72:75], v[116:119], v[96:99], v[72:75]
    ds_read_b64_tr_b16 v[148:149], v19 offset:57344
    ds_read_b64_tr_b16 v[150:151], v19 offset:57856
    v_mfma_f32_16x16x32_bf16 v[76:79], v[116:119], v[100:103], v[76:79]
    ds_read_b128 v[136:139], v17 offset:49152
    ds_read_b64_tr_b16 v[152:153], v18 offset:61440
    s_mov_b32 s66, 1179648
    s_add_u32 m0, s75, 40960
    s_nop 0
    buffer_load_dwordx4 v12, s[36:39], s66 offen lds
    v_mfma_f32_16x16x32_bf16 v[64:67], v[120:123], v[104:107], v[64:67]
    ds_read_b64_tr_b16 v[154:155], v18 offset:61952
    v_mfma_f32_16x16x32_bf16 v[68:71], v[120:123], v[108:111], v[68:71]
    ds_read_b128 v[140:143], v17 offset:51200
    s_movk_i32 s66, 2304
    s_add_u32 m0, s75, 33792
    s_nop 0
    buffer_load_dwordx4 v11, s[20:23], s66 offen sc1 lds
    v_mfma_f32_16x16x32_bf16 v[72:75], v[124:127], v[104:107], v[72:75]
    ds_read_b64_tr_b16 v[156:157], v19 offset:61440
    v_mfma_f32_16x16x32_bf16 v[76:79], v[124:127], v[108:111], v[76:79]
    ds_read_b64_tr_b16 v[158:159], v19 offset:61952
    s_mov_b32 s66, 1179648
    s_add_u32 m0, s75, 41984
    s_nop 0
    buffer_load_dwordx4 v13, s[36:39], s66 offen lds
    s_waitcnt vmcnt(8)
    s_waitcnt lgkmcnt(0)
    s_barrier
    v_mfma_f32_16x16x32_bf16 v[64:67], v[144:147], v[128:131], v[64:67]
    ds_read_b128 v[96:99], v16 offset:0
    ds_read_b64_tr_b16 v[112:113], v18 offset:8192
    v_mfma_f32_16x16x32_bf16 v[68:71], v[144:147], v[132:135], v[68:71]
    ds_read_b64_tr_b16 v[114:115], v18 offset:8704
    ds_read_b128 v[100:103], v16 offset:2048
    s_movk_i32 s66, 2432
    s_add_u32 m0, s75, 49152
    s_nop 0
    buffer_load_dwordx4 v10, s[20:23], s66 offen sc1 lds
    v_mfma_f32_16x16x32_bf16 v[72:75], v[148:151], v[128:131], v[72:75]
    ds_read_b64_tr_b16 v[116:117], v19 offset:8192
    ds_read_b64_tr_b16 v[118:119], v19 offset:8704
    v_mfma_f32_16x16x32_bf16 v[76:79], v[148:151], v[132:135], v[76:79]
    ds_read_b128 v[104:107], v17 offset:0
    ds_read_b64_tr_b16 v[120:121], v18 offset:12288
    s_mov_b32 s66, 1245184
    s_add_u32 m0, s75, 57344
    s_nop 0
    buffer_load_dwordx4 v12, s[36:39], s66 offen lds
    v_mfma_f32_16x16x32_bf16 v[64:67], v[152:155], v[136:139], v[64:67]
    ds_read_b64_tr_b16 v[122:123], v18 offset:12800
    v_mfma_f32_16x16x32_bf16 v[68:71], v[152:155], v[140:143], v[68:71]
    ds_read_b128 v[108:111], v17 offset:2048
    s_movk_i32 s66, 2432
    s_add_u32 m0, s75, 50176
    s_nop 0
    buffer_load_dwordx4 v11, s[20:23], s66 offen sc1 lds
    v_mfma_f32_16x16x32_bf16 v[72:75], v[156:159], v[136:139], v[72:75]
    ds_read_b64_tr_b16 v[124:125], v19 offset:12288
    v_mfma_f32_16x16x32_bf16 v[76:79], v[156:159], v[140:143], v[76:79]
    ds_read_b64_tr_b16 v[126:127], v19 offset:12800
    s_mov_b32 s66, 1245184
    s_add_u32 m0, s75, 58368
    s_nop 0
    buffer_load_dwordx4 v13, s[36:39], s66 offen lds
    s_waitcnt vmcnt(8)
    s_waitcnt lgkmcnt(0)
    s_barrier
    v_mfma_f32_16x16x32_bf16 v[64:67], v[112:115], v[96:99], v[64:67]
    ds_read_b128 v[128:131], v16 offset:16384
    ds_read_b64_tr_b16 v[144:145], v18 offset:24576
    v_mfma_f32_16x16x32_bf16 v[68:71], v[112:115], v[100:103], v[68:71]
    ds_read_b64_tr_b16 v[146:147], v18 offset:25088
    ds_read_b128 v[132:135], v16 offset:18432
    s_movk_i32 s66, 2560
    s_add_u32 m0, s75, 0
    s_nop 0
    buffer_load_dwordx4 v10, s[20:23], s66 offen sc1 lds
    v_mfma_f32_16x16x32_bf16 v[72:75], v[116:119], v[96:99], v[72:75]
    ds_read_b64_tr_b16 v[148:149], v19 offset:24576
    ds_read_b64_tr_b16 v[150:151], v19 offset:25088
    v_mfma_f32_16x16x32_bf16 v[76:79], v[116:119], v[100:103], v[76:79]
    ds_read_b128 v[136:139], v17 offset:16384
    ds_read_b64_tr_b16 v[152:153], v18 offset:28672
    s_mov_b32 s66, 1310720
    s_add_u32 m0, s75, 8192
    s_nop 0
    buffer_load_dwordx4 v12, s[36:39], s66 offen lds
    v_mfma_f32_16x16x32_bf16 v[64:67], v[120:123], v[104:107], v[64:67]
    ds_read_b64_tr_b16 v[154:155], v18 offset:29184
    v_mfma_f32_16x16x32_bf16 v[68:71], v[120:123], v[108:111], v[68:71]
    ds_read_b128 v[140:143], v17 offset:18432
    s_movk_i32 s66, 2560
    s_add_u32 m0, s75, 1024
    s_nop 0
    buffer_load_dwordx4 v11, s[20:23], s66 offen sc1 lds
    v_mfma_f32_16x16x32_bf16 v[72:75], v[124:127], v[104:107], v[72:75]
    ds_read_b64_tr_b16 v[156:157], v19 offset:28672
    v_mfma_f32_16x16x32_bf16 v[76:79], v[124:127], v[108:111], v[76:79]
    ds_read_b64_tr_b16 v[158:159], v19 offset:29184
    s_mov_b32 s66, 1310720
    s_add_u32 m0, s75, 9216
    s_nop 0
    buffer_load_dwordx4 v13, s[36:39], s66 offen lds
    s_waitcnt vmcnt(8)
    s_waitcnt lgkmcnt(0)
    s_barrier
    v_mfma_f32_16x16x32_bf16 v[64:67], v[144:147], v[128:131], v[64:67]
    ds_read_b128 v[96:99], v16 offset:32768
    ds_read_b64_tr_b16 v[112:113], v18 offset:40960
    v_mfma_f32_16x16x32_bf16 v[68:71], v[144:147], v[132:135], v[68:71]
    ds_read_b64_tr_b16 v[114:115], v18 offset:41472
    ds_read_b128 v[100:103], v16 offset:34816
    s_movk_i32 s66, 2688
    s_add_u32 m0, s75, 16384
    s_nop 0
    buffer_load_dwordx4 v10, s[20:23], s66 offen sc1 lds
    v_mfma_f32_16x16x32_bf16 v[72:75], v[148:151], v[128:131], v[72:75]
    ds_read_b64_tr_b16 v[116:117], v19 offset:40960
    ds_read_b64_tr_b16 v[118:119], v19 offset:41472
    v_mfma_f32_16x16x32_bf16 v[76:79], v[148:151], v[132:135], v[76:79]
    ds_read_b128 v[104:107], v17 offset:32768
    ds_read_b64_tr_b16 v[120:121], v18 offset:45056
    s_mov_b32 s66, 1376256
    s_add_u32 m0, s75, 24576
    s_nop 0
    buffer_load_dwordx4 v12, s[36:39], s66 offen lds
    v_mfma_f32_16x16x32_bf16 v[64:67], v[152:155], v[136:139], v[64:67]
    ds_read_b64_tr_b16 v[122:123], v18 offset:45568
    v_mfma_f32_16x16x32_bf16 v[68:71], v[152:155], v[140:143], v[68:71]
    ds_read_b128 v[108:111], v17 offset:34816
    s_movk_i32 s66, 2688
    s_add_u32 m0, s75, 17408
    s_nop 0
    buffer_load_dwordx4 v11, s[20:23], s66 offen sc1 lds
    v_mfma_f32_16x16x32_bf16 v[72:75], v[156:159], v[136:139], v[72:75]
    ds_read_b64_tr_b16 v[124:125], v19 offset:45056
    v_mfma_f32_16x16x32_bf16 v[76:79], v[156:159], v[140:143], v[76:79]
    ds_read_b64_tr_b16 v[126:127], v19 offset:45568
    s_mov_b32 s66, 1376256
    s_add_u32 m0, s75, 25600
    s_nop 0
    buffer_load_dwordx4 v13, s[36:39], s66 offen lds
    s_waitcnt vmcnt(8)
    s_waitcnt lgkmcnt(0)
    s_barrier
    v_mfma_f32_16x16x32_bf16 v[64:67], v[112:115], v[96:99], v[64:67]
    ds_read_b128 v[128:131], v16 offset:49152
    ds_read_b64_tr_b16 v[144:145], v18 offset:57344
    v_mfma_f32_16x16x32_bf16 v[68:71], v[112:115], v[100:103], v[68:71]
    ds_read_b64_tr_b16 v[146:147], v18 offset:57856
    ds_read_b128 v[132:135], v16 offset:51200
    s_movk_i32 s66, 2816
    s_add_u32 m0, s75, 32768
    s_nop 0
    buffer_load_dwordx4 v10, s[20:23], s66 offen sc1 lds
    v_mfma_f32_16x16x32_bf16 v[72:75], v[116:119], v[96:99], v[72:75]
    ds_read_b64_tr_b16 v[148:149], v19 offset:57344
    ds_read_b64_tr_b16 v[150:151], v19 offset:57856
    v_mfma_f32_16x16x32_bf16 v[76:79], v[116:119], v[100:103], v[76:79]
    ds_read_b128 v[136:139], v17 offset:49152
    ds_read_b64_tr_b16 v[152:153], v18 offset:61440
    s_mov_b32 s66, 1441792
    s_add_u32 m0, s75, 40960
    s_nop 0
    buffer_load_dwordx4 v12, s[36:39], s66 offen lds
    v_mfma_f32_16x16x32_bf16 v[64:67], v[120:123], v[104:107], v[64:67]
    ds_read_b64_tr_b16 v[154:155], v18 offset:61952
    v_mfma_f32_16x16x32_bf16 v[68:71], v[120:123], v[108:111], v[68:71]
    ds_read_b128 v[140:143], v17 offset:51200
    s_movk_i32 s66, 2816
    s_add_u32 m0, s75, 33792
    s_nop 0
    buffer_load_dwordx4 v11, s[20:23], s66 offen sc1 lds
    v_mfma_f32_16x16x32_bf16 v[72:75], v[124:127], v[104:107], v[72:75]
    ds_read_b64_tr_b16 v[156:157], v19 offset:61440
    v_mfma_f32_16x16x32_bf16 v[76:79], v[124:127], v[108:111], v[76:79]
    ds_read_b64_tr_b16 v[158:159], v19 offset:61952
    s_mov_b32 s66, 1441792
    s_add_u32 m0, s75, 41984
    s_nop 0
    buffer_load_dwordx4 v13, s[36:39], s66 offen lds
    s_waitcnt vmcnt(8)
    s_waitcnt lgkmcnt(0)
    s_barrier
    v_mfma_f32_16x16x32_bf16 v[64:67], v[144:147], v[128:131], v[64:67]
    ds_read_b128 v[96:99], v16 offset:0
    ds_read_b64_tr_b16 v[112:113], v18 offset:8192
    v_mfma_f32_16x16x32_bf16 v[68:71], v[144:147], v[132:135], v[68:71]
    ds_read_b64_tr_b16 v[114:115], v18 offset:8704
    ds_read_b128 v[100:103], v16 offset:2048
    s_movk_i32 s66, 2944
    s_add_u32 m0, s75, 49152
    s_nop 0
    buffer_load_dwordx4 v10, s[20:23], s66 offen sc1 lds
    v_mfma_f32_16x16x32_bf16 v[72:75], v[148:151], v[128:131], v[72:75]
    ds_read_b64_tr_b16 v[116:117], v19 offset:8192
    ds_read_b64_tr_b16 v[118:119], v19 offset:8704
    v_mfma_f32_16x16x32_bf16 v[76:79], v[148:151], v[132:135], v[76:79]
    ds_read_b128 v[104:107], v17 offset:0
    ds_read_b64_tr_b16 v[120:121], v18 offset:12288
    s_mov_b32 s66, 1507328
    s_add_u32 m0, s75, 57344
    s_nop 0
    buffer_load_dwordx4 v12, s[36:39], s66 offen lds
    v_mfma_f32_16x16x32_bf16 v[64:67], v[152:155], v[136:139], v[64:67]
    ds_read_b64_tr_b16 v[122:123], v18 offset:12800
    v_mfma_f32_16x16x32_bf16 v[68:71], v[152:155], v[140:143], v[68:71]
    ds_read_b128 v[108:111], v17 offset:2048
    s_movk_i32 s66, 2944
    s_add_u32 m0, s75, 50176
    s_nop 0
    buffer_load_dwordx4 v11, s[20:23], s66 offen sc1 lds
    v_mfma_f32_16x16x32_bf16 v[72:75], v[156:159], v[136:139], v[72:75]
    ds_read_b64_tr_b16 v[124:125], v19 offset:12288
    v_mfma_f32_16x16x32_bf16 v[76:79], v[156:159], v[140:143], v[76:79]
    ds_read_b64_tr_b16 v[126:127], v19 offset:12800
    s_mov_b32 s66, 1507328
    s_add_u32 m0, s75, 58368
    s_nop 0
    buffer_load_dwordx4 v13, s[36:39], s66 offen lds
    s_and_b32 s64, s2, 7
    s_lshl_b32 s64, s64, 10
    s_lshl_b32 s65, s71, 7
    s_add_u32 s64, s64, s65
    s_add_u32 s64, s64, 16384
    v_and_b32 v22, 31, v4
    v_lshlrev_b32 v22, 2, v22
    v_add_u32 v22, s64, v22
    s_cmp_lg_u32 s68, 0
    s_cbranch_scc1 PI_15
    buffer_load_dword v23, v22, s[4:7], 0 offen sc1
PI_15:
    s_waitcnt vmcnt(8)
    s_waitcnt lgkmcnt(0)
    s_barrier
    v_mfma_f32_16x16x32_bf16 v[64:67], v[112:115], v[96:99], v[64:67]
    ds_read_b128 v[128:131], v16 offset:16384
    ds_read_b64_tr_b16 v[144:145], v18 offset:24576
    v_mfma_f32_16x16x32_bf16 v[68:71], v[112:115], v[100:103], v[68:71]
    ds_read_b64_tr_b16 v[146:147], v18 offset:25088
    ds_read_b128 v[132:135], v16 offset:18432
    s_movk_i32 s66, 3072
    s_add_u32 m0, s75, 0
    s_nop 0
    buffer_load_dwordx4 v10, s[20:23], s66 offen sc1 lds
    v_mfma_f32_16x16x32_bf16 v[72:75], v[116:119], v[96:99], v[72:75]
    ds_read_b64_tr_b16 v[148:149], v19 offset:24576
    ds_read_b64_tr_b16 v[150:151], v19 offset:25088
    v_mfma_f32_16x16x32_bf16 v[76:79], v[116:119], v[100:103], v[76:79]
    ds_read_b128 v[136:139], v17 offset:16384
    ds_read_b64_tr_b16 v[152:153], v18 offset:28672
    s_mov_b32 s66, 1572864
    s_add_u32 m0, s75, 8192
    s_nop 0
    buffer_load_dwordx4 v12, s[36:39], s66 offen lds
    v_mfma_f32_16x16x32_bf16 v[64:67], v[120:123], v[104:107], v[64:67]
    ds_read_b64_tr_b16 v[154:155], v18 offset:29184
    v_mfma_f32_16x16x32_bf16 v[68:71], v[120:123], v[108:111], v[68:71]
    ds_read_b128 v[140:143], v17 offset:18432
    s_movk_i32 s66, 3072
    s_add_u32 m0, s75, 1024
    s_nop 0
    buffer_load_dwordx4 v11, s[20:23], s66 offen sc1 lds
    v_mfma_f32_16x16x32_bf16 v[72:75], v[124:127], v[104:107], v[72:75]
    ds_read_b64_tr_b16 v[156:157], v19 offset:28672
    v_mfma_f32_16x16x32_bf16 v[76:79], v[124:127], v[108:111], v[76:79]
    ds_read_b64_tr_b16 v[158:159], v19 offset:29184
    s_mov_b32 s66, 1572864
    s_add_u32 m0, s75, 9216
    s_nop 0
    buffer_load_dwordx4 v13, s[36:39], s66 offen lds
    s_waitcnt vmcnt(8)
    s_waitcnt lgkmcnt(0)
    s_barrier
    v_mfma_f32_16x16x32_bf16 v[64:67], v[144:147], v[128:131], v[64:67]
    ds_read_b128 v[96:99], v16 offset:32768
    ds_read_b64_tr_b16 v[112:113], v18 offset:40960
    v_mfma_f32_16x16x32_bf16 v[68:71], v[144:147], v[132:135], v[68:71]
    ds_read_b64_tr_b16 v[114:115], v18 offset:41472
    ds_read_b128 v[100:103], v16 offset:34816
    s_movk_i32 s66, 3200
    s_add_u32 m0, s75, 16384
    s_nop 0
    buffer_load_dwordx4 v10, s[20:23], s66 offen sc1 lds
    v_mfma_f32_16x16x32_bf16 v[72:75], v[148:151], v[128:131], v[72:75]
    ds_read_b64_tr_b16 v[116:117], v19 offset:40960
    ds_read_b64_tr_b16 v[118:119], v19 offset:41472
    v_mfma_f32_16x16x32_bf16 v[76:79], v[148:151], v[132:135], v[76:79]
    ds_read_b128 v[104:107], v17 offset:32768
    ds_read_b64_tr_b16 v[120:121], v18 offset:45056
    s_mov_b32 s66, 1638400
    s_add_u32 m0, s75, 24576
    s_nop 0
    buffer_load_dwordx4 v12, s[36:39], s66 offen lds
    v_mfma_f32_16x16x32_bf16 v[64:67], v[152:155], v[136:139], v[64:67]
    ds_read_b64_tr_b16 v[122:123], v18 offset:45568
    v_mfma_f32_16x16x32_bf16 v[68:71], v[152:155], v[140:143], v[68:71]
    ds_read_b128 v[108:111], v17 offset:34816
    s_movk_i32 s66, 3200
    s_add_u32 m0, s75, 17408
    s_nop 0
    buffer_load_dwordx4 v11, s[20:23], s66 offen sc1 lds
    v_mfma_f32_16x16x32_bf16 v[72:75], v[156:159], v[136:139], v[72:75]
    ds_read_b64_tr_b16 v[124:125], v19 offset:45056
    v_mfma_f32_16x16x32_bf16 v[76:79], v[156:159], v[140:143], v[76:79]
    ds_read_b64_tr_b16 v[126:127], v19 offset:45568
    s_mov_b32 s66, 1638400
    s_add_u32 m0, s75, 25600
    s_nop 0
    buffer_load_dwordx4 v13, s[36:39], s66 offen lds
    s_waitcnt vmcnt(8)
    s_waitcnt lgkmcnt(0)
    s_barrier
    v_mfma_f32_16x16x32_bf16 v[64:67], v[112:115], v[96:99], v[64:67]
    ds_read_b128 v[128:131], v16 offset:49152
    ds_read_b64_tr_b16 v[144:145], v18 offset:57344
    v_mfma_f32_16x16x32_bf16 v[68:71], v[112:115], v[100:103], v[68:71]
    ds_read_b64_tr_b16 v[146:147], v18 offset:57856
    ds_read_b128 v[132:135], v16 offset:51200
    s_movk_i32 s66, 3328
    s_add_u32 m0, s75, 32768
    s_nop 0
    buffer_load_dwordx4 v10, s[20:23], s66 offen sc1 lds
    v_mfma_f32_16x16x32_bf16 v[72:75], v[116:119], v[96:99], v[72:75]
    ds_read_b64_tr_b16 v[148:149], v19 offset:57344
    ds_read_b64_tr_b16 v[150:151], v19 offset:57856
    v_mfma_f32_16x16x32_bf16 v[76:79], v[116:119], v[100:103], v[76:79]
    ds_read_b128 v[136:139], v17 offset:49152
    ds_read_b64_tr_b16 v[152:153], v18 offset:61440
    s_mov_b32 s66, 1703936
    s_add_u32 m0, s75, 40960
    s_nop 0
    buffer_load_dwordx4 v12, s[36:39], s66 offen lds
    v_mfma_f32_16x16x32_bf16 v[64:67], v[120:123], v[104:107], v[64:67]
    ds_read_b64_tr_b16 v[154:155], v18 offset:61952
    v_mfma_f32_16x16x32_bf16 v[68:71], v[120:123], v[108:111], v[68:71]
    ds_read_b128 v[140:143], v17 offset:51200
    s_movk_i32 s66, 3328
    s_add_u32 m0, s75, 33792
    s_nop 0
    buffer_load_dwordx4 v11, s[20:23], s66 offen sc1 lds
    v_mfma_f32_16x16x32_bf16 v[72:75], v[124:127], v[104:107], v[72:75]
    ds_read_b64_tr_b16 v[156:157], v19 offset:61440
    v_mfma_f32_16x16x32_bf16 v[76:79], v[124:127], v[108:111], v[76:79]
    ds_read_b64_tr_b16 v[158:159], v19 offset:61952
    s_mov_b32 s66, 1703936
    s_add_u32 m0, s75, 41984
    s_nop 0
    buffer_load_dwordx4 v13, s[36:39], s66 offen lds
    s_waitcnt vmcnt(8)
    s_waitcnt lgkmcnt(0)
    s_barrier
    v_mfma_f32_16x16x32_bf16 v[64:67], v[144:147], v[128:131], v[64:67]
    ds_read_b128 v[96:99], v16 offset:0
    ds_read_b64_tr_b16 v[112:113], v18 offset:8192
    v_mfma_f32_16x16x32_bf16 v[68:71], v[144:147], v[132:135], v[68:71]
    ds_read_b64_tr_b16 v[114:115], v18 offset:8704
    ds_read_b128 v[100:103], v16 offset:2048
    s_movk_i32 s66, 3456
    s_add_u32 m0, s75, 49152
    s_nop 0
    buffer_load_dwordx4 v10, s[20:23], s66 offen sc1 lds
    v_mfma_f32_16x16x32_bf16 v[72:75], v[148:151], v[128:131], v[72:75]
    ds_read_b64_tr_b16 v[116:117], v19 offset:8192
    ds_read_b64_tr_b16 v[118:119], v19 offset:8704
    v_mfma_f32_16x16x32_bf16 v[76:79], v[148:151], v[132:135], v[76:79]
    ds_read_b128 v[104:107], v17 offset:0
    ds_read_b64_tr_b16 v[120:121], v18 offset:12288
    s_mov_b32 s66, 1769472
    s_add_u32 m0, s75, 57344
    s_nop 0
    buffer_load_dwordx4 v12, s[36:39], s66 offen lds
    v_mfma_f32_16x16x32_bf16 v[64:67], v[152:155], v[136:139], v[64:67]
    ds_read_b64_tr_b16 v[122:123], v18 offset:12800
    v_mfma_f32_16x16x32_bf16 v[68:71], v[152:155], v[140:143], v[68:71]
    ds_read_b128 v[108:111], v17 offset:2048
    s_movk_i32 s66, 3456
    s_add_u32 m0, s75, 50176
    s_nop 0
    buffer_load_dwordx4 v11, s[20:23], s66 offen sc1 lds
    v_mfma_f32_16x16x32_bf16 v[72:75], v[156:159], v[136:139], v[72:75]
    ds_read_b64_tr_b16 v[124:125], v19 offset:12288
    v_mfma_f32_16x16x32_bf16 v[76:79], v[156:159], v[140:143], v[76:79]
    ds_read_b64_tr_b16 v[126:127], v19 offset:12800
    s_mov_b32 s66, 1769472
    s_add_u32 m0, s75, 58368
    s_nop 0
    buffer_load_dwordx4 v13, s[36:39], s66 offen lds
    s_waitcnt vmcnt(8)
    s_waitcnt lgkmcnt(0)
    s_barrier
    v_mfma_f32_16x16x32_bf16 v[64:67], v[112:115], v[96:99], v[64:67]
    ds_read_b128 v[128:131], v16 offset:16384
    ds_read_b64_tr_b16 v[144:145], v18 offset:24576
    v_mfma_f32_16x16x32_bf16 v[68:71], v[112:115], v[100:103], v[68:71]
    ds_read_b64_tr_b16 v[146:147], v18 offset:25088
    ds_read_b128 v[132:135], v16 offset:18432
    v_mfma_f32_16x16x32_bf16 v[72:75], v[116:119], v[96:99], v[72:75]
    ds_read_b64_tr_b16 v[148:149], v19 offset:24576
    ds_read_b64_tr_b16 v[150:151], v19 offset:25088
    v_mfma_f32_16x16x32_bf16 v[76:79], v[116:119], v[100:103], v[76:79]
    ds_read_b128 v[136:139], v17 offset:16384
    ds_read_b64_tr_b16 v[152:153], v18 offset:28672
    v_mfma_f32_16x16x32_bf16 v[64:67], v[120:123], v[104:107], v[64:67]
    ds_read_b64_tr_b16 v[154:155], v18 offset:29184
    v_mfma_f32_16x16x32_bf16 v[68:71], v[120:123], v[108:111], v[68:71]
    ds_read_b128 v[140:143], v17 offset:18432
    v_mfma_f32_16x16x32_bf16 v[72:75], v[124:127], v[104:107], v[72:75]
    ds_read_b64_tr_b16 v[156:157], v19 offset:28672
    v_mfma_f32_16x16x32_bf16 v[76:79], v[124:127], v[108:111], v[76:79]
    ds_read_b64_tr_b16 v[158:159], v19 offset:29184
    s_waitcnt vmcnt(4)
    s_waitcnt lgkmcnt(0)
    s_cmp_lg_u32 s68, 0
    s_cbranch_scc1 POLLE_17
    s_waitcnt vmcnt(16)
    s_mov_b32 s66, 0
POLL_16:
    v_cmp_ne_u32 vcc, s83, v23
    s_add_u32 s66, s66, 1
    s_nop 1
    s_cmp_eq_u64 vcc, 0
    s_cbranch_scc1 POLLE_17
    s_cmp_gt_u32 s66, 0x40000
    s_cbranch_scc1 POLLE_17
    s_sleep 12
    buffer_load_dword v23, v22, s[4:7], 0 offen sc1
    s_waitcnt vmcnt(0)
    s_branch POLL_16
POLLE_17:
    s_barrier
    v_mfma_f32_16x16x32_bf16 v[64:67], v[144:147], v[128:131], v[64:67]
    ds_read_b128 v[96:99], v16 offset:32768
    ds_read_b64_tr_b16 v[112:113], v18 offset:40960
    v_mfma_f32_16x16x32_bf16 v[68:71], v[144:147], v[132:135], v[68:71]
    ds_read_b64_tr_b16 v[114:115], v18 offset:41472
    ds_read_b128 v[100:103], v16 offset:34816
    s_mov_b32 s66, 0
    s_add_u32 m0, s75, 16384
    s_nop 0
    buffer_load_dwordx4 v15, s[24:27], s66 offen sc1 lds
    v_mfma_f32_16x16x32_bf16 v[72:75], v[148:151], v[128:131], v[72:75]
    ds_read_b64_tr_b16 v[116:117], v19 offset:40960
    ds_read_b64_tr_b16 v[118:119], v19 offset:41472
    v_mfma_f32_16x16x32_bf16 v[76:79], v[148:151], v[132:135], v[76:79]
    ds_read_b128 v[104:107], v17 offset:32768
    ds_read_b64_tr_b16 v[120:121], v18 offset:45056
    s_mov_b32 s66, 32768
    s_add_u32 m0, s75, 17408
    s_nop 0
    buffer_load_dwordx4 v15, s[24:27], s66 offen sc1 lds
    v_mfma_f32_16x16x32_bf16 v[64:67], v[152:155], v[136:139], v[64:67]
    ds_read_b64_tr_b16 v[122:123], v18 offset:45568
    v_mfma_f32_16x16x32_bf16 v[68:71], v[152:155], v[140:143], v[68:71]
    ds_read_b128 v[108:111], v17 offset:34816
    v_mfma_f32_16x16x32_bf16 v[72:75], v[156:159], v[136:139], v[72:75]
    ds_read_b64_tr_b16 v[124:125], v19 offset:45056
    v_mfma_f32_16x16x32_bf16 v[76:79], v[156:159], v[140:143], v[76:79]
    ds_read_b64_tr_b16 v[126:127], v19 offset:45568
    s_waitcnt vmcnt(2)
    s_waitcnt lgkmcnt(0)
    s_barrier
    v_mfma_f32_16x16x32_bf16 v[64:67], v[112:115], v[96:99], v[64:67]
    ds_read_b128 v[128:131], v16 offset:49152
    ds_read_b64_tr_b16 v[144:145], v18 offset:57344
    v_mfma_f32_16x16x32_bf16 v[68:71], v[112:115], v[100:103], v[68:71]
    ds_read_b64_tr_b16 v[146:147], v18 offset:57856
    ds_read_b128 v[132:135], v16 offset:51200
    v_mfma_f32_16x16x32_bf16 v[72:75], v[116:119], v[96:99], v[72:75]
    ds_read_b64_tr_b16 v[148:149], v19 offset:57344
    ds_read_b64_tr_b16 v[150:151], v19 offset:57856
    v_mfma_f32_16x16x32_bf16 v[76:79], v[116:119], v[100:103], v[76:79]
    ds_read_b128 v[136:139], v17 offset:49152
    ds_read_b64_tr_b16 v[152:153], v18 offset:61440
    v_mfma_f32_16x16x32_bf16 v[64:67], v[120:123], v[104:107], v[64:67]
    ds_read_b64_tr_b16 v[154:155], v18 offset:61952
    v_mfma_f32_16x16x32_bf16 v[68:71], v[120:123], v[108:111], v[68:71]
    ds_read_b128 v[140:143], v17 offset:51200
    v_mfma_f32_16x16x32_bf16 v[72:75], v[124:127], v[104:107], v[72:75]
    ds_read_b64_tr_b16 v[156:157], v19 offset:61440
    v_mfma_f32_16x16x32_bf16 v[76:79], v[124:127], v[108:111], v[76:79]
    ds_read_b64_tr_b16 v[158:159], v19 offset:61952
    s_waitcnt lgkmcnt(0)
    s_barrier
    v_mfma_f32_16x16x32_bf16 v[64:67], v[144:147], v[128:131], v[64:67]
    v_mfma_f32_16x16x32_bf16 v[68:71], v[144:147], v[132:135], v[68:71]
    v_mfma_f32_16x16x32_bf16 v[72:75], v[148:151], v[128:131], v[72:75]
    v_mfma_f32_16x16x32_bf16 v[76:79], v[148:151], v[132:135], v[76:79]
    v_mfma_f32_16x16x32_bf16 v[64:67], v[152:155], v[136:139], v[64:67]
    v_mfma_f32_16x16x32_bf16 v[68:71], v[152:155], v[140:143], v[68:71]
    v_mfma_f32_16x16x32_bf16 v[72:75], v[156:159], v[136:139], v[72:75]
    v_mfma_f32_16x16x32_bf16 v[76:79], v[156:159], v[140:143], v[76:79]
    s_waitcnt vmcnt(0)
    s_barrier
    s_lshl_b32 s66, s77, 12
    s_lshl_b32 s65, s78, 6
    s_add_u32 s66, s66, s65
    s_add_u32 s66, s66, 65536
    v_lshlrev_b32 v5, 7, v1
    v_lshl_add_u32 v5, v2, 3, v5
    v_add_u32 v5, s66, v5
    ds_read_b64 v[128:129], v5 offset:0
    ds_read_b64 v[136:137], v5 offset:8192
    ds_read_b64 v[130:131], v5 offset:32
    ds_read_b64 v[138:139], v5 offset:8224
    ds_read_b64 v[132:133], v5 offset:2048
    ds_read_b64 v[140:141], v5 offset:10240
    ds_read_b64 v[134:135], v5 offset:2080
    ds_read_b64 v[142:143], v5 offset:10272
    v_lshrrev_b32 v6, 2, v1
    v_lshl_add_u32 v6, v2, 2, v6
    v_lshlrev_b32 v6, 7, v6
    v_and_b32 v9, 3, v0
    v_lshl_add_u32 v6, v9, 3, v6
    s_lshl_b32 s66, s78, 12
    s_lshl_b32 s65, s77, 6
    s_add_u32 s66, s66, s65
    s_add_u32 s66, s66, 16384
    v_add_u32 v6, s66, v6
    ds_read_b64_tr_b16 v[144:145], v6 offset:0
    ds_read_b64_tr_b16 v[146:147], v6 offset:2048
    ds_read_b64_tr_b16 v[148:149], v6 offset:32
    ds_read_b64_tr_b16 v[150:151], v6 offset:2080
    s_mov_b32 s67, 0xffff0000
    s_waitcnt lgkmcnt(0)
    v_cvt_pk_bf16_f32 v210, v64, v65
    v_lshlrev_b32 v211, 16, v136
    v_and_b32 v212, s67, v136
    v_lshlrev_b32 v213, 16, v24
    v_and_b32 v214, s67, v24
    v_mul_f32 v211, v211, v213
    v_mul_f32 v212, v212, v214
    v_cvt_pk_bf16_f32 v211, v211, v212
    v_lshlrev_b32 v212, 16, v211
    v_and_b32 v211, s67, v211
    v_lshlrev_b32 v213, 16, v144
    v_and_b32 v214, s67, v144
    v_add_f32 v212, v213, v212
    v_add_f32 v211, v214, v211
    v_cvt_pk_bf16_f32 v211, v212, v211
    v_lshlrev_b32 v212, 16, v211
    v_and_b32 v211, s67, v211
    v_lshlrev_b32 v213, 16, v128
    v_and_b32 v214, s67, v128
    v_add_f32 v212, v213, v212
    v_add_f32 v211, v214, v211
    v_cvt_pk_bf16_f32 v211, v212, v211
    v_lshlrev_b32 v212, 16, v211
    v_and_b32 v211, s67, v211
    v_lshlrev_b32 v213, 16, v210
    v_and_b32 v214, s67, v210
    v_add_f32 v212, v212, v213
    v_add_f32 v211, v211, v214
    v_cvt_pk_bf16_f32 v152, v212, v211
    v_cvt_pk_bf16_f32 v210, v66, v67
    v_lshlrev_b32 v211, 16, v137
    v_and_b32 v212, s67, v137
    v_lshlrev_b32 v213, 16, v25
    v_and_b32 v214, s67, v25
    v_mul_f32 v211, v211, v213
    v_mul_f32 v212, v212, v214
    v_cvt_pk_bf16_f32 v211, v211, v212
    v_lshlrev_b32 v212, 16, v211
    v_and_b32 v211, s67, v211
    v_lshlrev_b32 v213, 16, v145
    v_and_b32 v214, s67, v145
    v_add_f32 v212, v213, v212
    v_add_f32 v211, v214, v211
    v_cvt_pk_bf16_f32 v211, v212, v211
    v_lshlrev_b32 v212, 16, v211
    v_and_b32 v211, s67, v211
    v_lshlrev_b32 v213, 16, v129
    v_and_b32 v214, s67, v129
    v_add_f32 v212, v213, v212
    v_add_f32 v211, v214, v211
    v_cvt_pk_bf16_f32 v211, v212, v211
    v_lshlrev_b32 v212, 16, v211
    v_and_b32 v211, s67, v211
    v_lshlrev_b32 v213, 16, v210
    v_and_b32 v214, s67, v210
    v_add_f32 v212, v212, v213
    v_add_f32 v211, v211, v214
    v_cvt_pk_bf16_f32 v153, v212, v211
    ds_write_b64 v5, v[152:153] offset:0
    v_cvt_pk_bf16_f32 v210, v72, v73
    v_lshlrev_b32 v211, 16, v138
    v_and_b32 v212, s67, v138
    v_lshlrev_b32 v213, 16, v26
    v_and_b32 v214, s67, v26
    v_mul_f32 v211, v211, v213
    v_mul_f32 v212, v212, v214
    v_cvt_pk_bf16_f32 v211, v211, v212
    v_lshlrev_b32 v212, 16, v211
    v_and_b32 v211, s67, v211
    v_lshlrev_b32 v213, 16, v146
    v_and_b32 v214, s67, v146
    v_add_f32 v212, v213, v212
    v_add_f32 v211, v214, v211
    v_cvt_pk_bf16_f32 v211, v212, v211
    v_lshlrev_b32 v212, 16, v211
    v_and_b32 v211, s67, v211
    v_lshlrev_b32 v213, 16, v130
    v_and_b32 v214, s67, v130
    v_add_f32 v212, v213, v212
    v_add_f32 v211, v214, v211
    v_cvt_pk_bf16_f32 v211, v212, v211
    v_lshlrev_b32 v212, 16, v211
    v_and_b32 v211, s67, v211
    v_lshlrev_b32 v213, 16, v210
    v_and_b32 v214, s67, v210
    v_add_f32 v212, v212, v213
    v_add_f32 v211, v211, v214
    v_cvt_pk_bf16_f32 v154, v212, v211
    v_cvt_pk_bf16_f32 v210, v74, v75
    v_lshlrev_b32 v211, 16, v139
    v_and_b32 v212, s67, v139
    v_lshlrev_b32 v213, 16, v27
    v_and_b32 v214, s67, v27
    v_mul_f32 v211, v211, v213
    v_mul_f32 v212, v212, v214
    v_cvt_pk_bf16_f32 v211, v211, v212
    v_lshlrev_b32 v212, 16, v211
    v_and_b32 v211, s67, v211
    v_lshlrev_b32 v213, 16, v147
    v_and_b32 v214, s67, v147
    v_add_f32 v212, v213, v212
    v_add_f32 v211, v214, v211
    v_cvt_pk_bf16_f32 v211, v212, v211
    v_lshlrev_b32 v212, 16, v211
    v_and_b32 v211, s67, v211
    v_lshlrev_b32 v213, 16, v131
    v_and_b32 v214, s67, v131
    v_add_f32 v212, v213, v212
    v_add_f32 v211, v214, v211
    v_cvt_pk_bf16_f32 v211, v212, v211
    v_lshlrev_b32 v212, 16, v211
    v_and_b32 v211, s67, v211
    v_lshlrev_b32 v213, 16, v210
    v_and_b32 v214, s67, v210
    v_add_f32 v212, v212, v213
    v_add_f32 v211, v211, v214
    v_cvt_pk_bf16_f32 v155, v212, v211
    ds_write_b64 v5, v[154:155] offset:32
    v_cvt_pk_bf16_f32 v210, v68, v69
    v_lshlrev_b32 v211, 16, v140
    v_and_b32 v212, s67, v140
    v_lshlrev_b32 v213, 16, v24
    v_and_b32 v214, s67, v24
    v_mul_f32 v211, v211, v213
    v_mul_f32 v212, v212, v214
    v_cvt_pk_bf16_f32 v211, v211, v212
    v_lshlrev_b32 v212, 16, v211
    v_and_b32 v211, s67, v211
    v_lshlrev_b32 v213, 16, v148
    v_and_b32 v214, s67, v148
    v_add_f32 v212, v213, v212
    v_add_f32 v211, v214, v211
    v_cvt_pk_bf16_f32 v211, v212, v211
    v_lshlrev_b32 v212, 16, v211
    v_and_b32 v211, s67, v211
    v_lshlrev_b32 v213, 16, v132
    v_and_b32 v214, s67, v132
    v_add_f32 v212, v213, v212
    v_add_f32 v211, v214, v211
    v_cvt_pk_bf16_f32 v211, v212, v211
    v_lshlrev_b32 v212, 16, v211
    v_and_b32 v211, s67, v211
    v_lshlrev_b32 v213, 16, v210
    v_and_b32 v214, s67, v210
    v_add_f32 v212, v212, v213
    v_add_f32 v211, v211, v214
    v_cvt_pk_bf16_f32 v156, v212, v211
    v_cvt_pk_bf16_f32 v210, v70, v71
    v_lshlrev_b32 v211, 16, v141
    v_and_b32 v212, s67, v141
    v_lshlrev_b32 v213, 16, v25
    v_and_b32 v214, s67, v25
    v_mul_f32 v211, v211, v213
    v_mul_f32 v212, v212, v214
    v_cvt_pk_bf16_f32 v211, v211, v212
    v_lshlrev_b32 v212, 16, v211
    v_and_b32 v211, s67, v211
    v_lshlrev_b32 v213, 16, v149
    v_and_b32 v214, s67, v149
    v_add_f32 v212, v213, v212
    v_add_f32 v211, v214, v211
    v_cvt_pk_bf16_f32 v211, v212, v211
    v_lshlrev_b32 v212, 16, v211
    v_and_b32 v211, s67, v211
    v_lshlrev_b32 v213, 16, v133
    v_and_b32 v214, s67, v133
    v_add_f32 v212, v213, v212
    v_add_f32 v211, v214, v211
    v_cvt_pk_bf16_f32 v211, v212, v211
    v_lshlrev_b32 v212, 16, v211
    v_and_b32 v211, s67, v211
    v_lshlrev_b32 v213, 16, v210
    v_and_b32 v214, s67, v210
    v_add_f32 v212, v212, v213
    v_add_f32 v211, v211, v214
    v_cvt_pk_bf16_f32 v157, v212, v211
    ds_write_b64 v5, v[156:157] offset:2048
    v_cvt_pk_bf16_f32 v210, v76, v77
    v_lshlrev_b32 v211, 16, v142
    v_and_b32 v212, s67, v142
    v_lshlrev_b32 v213, 16, v26
    v_and_b32 v214, s67, v26
    v_mul_f32 v211, v211, v213
    v_mul_f32 v212, v212, v214
    v_cvt_pk_bf16_f32 v211, v211, v212
    v_lshlrev_b32 v212, 16, v211
    v_and_b32 v211, s67, v211
    v_lshlrev_b32 v213, 16, v150
    v_and_b32 v214, s67, v150
    v_add_f32 v212, v213, v212
    v_add_f32 v211, v214, v211
    v_cvt_pk_bf16_f32 v211, v212, v211
    v_lshlrev_b32 v212, 16, v211
    v_and_b32 v211, s67, v211
    v_lshlrev_b32 v213, 16, v134
    v_and_b32 v214, s67, v134
    v_add_f32 v212, v213, v212
    v_add_f32 v211, v214, v211
    v_cvt_pk_bf16_f32 v211, v212, v211
    v_lshlrev_b32 v212, 16, v211
    v_and_b32 v211, s67, v211
    v_lshlrev_b32 v213, 16, v210
    v_and_b32 v214, s67, v210
    v_add_f32 v212, v212, v213
    v_add_f32 v211, v211, v214
    v_cvt_pk_bf16_f32 v158, v212, v211
    v_cvt_pk_bf16_f32 v210, v78, v79
    v_lshlrev_b32 v211, 16, v143
    v_and_b32 v212, s67, v143
    v_lshlrev_b32 v213, 16, v27
    v_and_b32 v214, s67, v27
    v_mul_f32 v211, v211, v213
    v_mul_f32 v212, v212, v214
    v_cvt_pk_bf16_f32 v211, v211, v212
    v_lshlrev_b32 v212, 16, v211
    v_and_b32 v211, s67, v211
    v_lshlrev_b32 v213, 16, v151
    v_and_b32 v214, s67, v151
    v_add_f32 v212, v213, v212
    v_add_f32 v211, v214, v211
    v_cvt_pk_bf16_f32 v211, v212, v211
    v_lshlrev_b32 v212, 16, v211
    v_and_b32 v211, s67, v211
    v_lshlrev_b32 v213, 16, v135
    v_and_b32 v214, s67, v135
    v_add_f32 v212, v213, v212
    v_add_f32 v211, v214, v211
    v_cvt_pk_bf16_f32 v211, v212, v211
    v_lshlrev_b32 v212, 16, v211
    v_and_b32 v211, s67, v211
    v_lshlrev_b32 v213, 16, v210
    v_and_b32 v214, s67, v210
    v_add_f32 v212, v212, v213
    v_add_f32 v211, v211, v214
    v_cvt_pk_bf16_f32 v159, v212, v211
    ds_write_b64 v5, v[158:159] offset:2080
    v_lshlrev_b32 v7, 4, v4
    v_add_u32 v7, s76, v7
    s_waitcnt lgkmcnt(0)
    s_barrier
    ds_read_b128 v[64:67], v7
    ds_read_b128 v[68:71], v7 offset:1024
    s_movk_i32 s66, 0x2000
    s_waitcnt lgkmcnt(0)
    buffer_store_dwordx4 v[64:67], v14, s[40:43], 0 offen
    buffer_store_dwordx4 v[68:71], v14, s[40:43], s66 offen
    s_endpgm
ROLE_S:
    s_mov_b32 s52, s70
    s_mov_b32 s53, s71
    s_and_b32 s53, s53, 0xffff
    s_mov_b32 s54, 131072
    s_mov_b32 s55, 0x00020000
    s_mov_b32 s56, s72
    s_mov_b32 s57, s73
    s_and_b32 s57, s57, 0xffff
    s_mov_b32 s58, 131072
    s_mov_b32 s59, 0x00020000
    s_mov_b32 s60, s74
    s_mov_b32 s61, s75
    s_and_b32 s61, s61, 0xffff
    s_mov_b32 s62, 131072
    s_mov_b32 s63, 0x00020000
    s_mov_b32 s64, s76
    s_mov_b32 s65, s77
    s_and_b32 s65, s65, 0xffff
    s_mov_b32 s66, 131072
    s_mov_b32 s67, 0x00020000
    v_and_b32 v7, 31, v4
    v_lshl_add_u32 v7, v3, 5, v7
    v_lshlrev_b32 v7, 1, v7
    s_lshl_b32 s3, s2, 9
    v_add_u32 v7, s3, v7
    buffer_load_ushort v240, v7, s[52:55], 0 offen offset:0
    buffer_load_ushort v241, v7, s[56:59], 0 offen offset:0
    buffer_load_ushort v242, v7, s[60:63], 0 offen offset:0
    buffer_load_ushort v243, v7, s[64:67], 0 offen offset:0
    buffer_load_ushort v244, v7, s[52:55], 0 offen offset:256
    buffer_load_ushort v245, v7, s[56:59], 0 offen offset:256
    buffer_load_ushort v246, v7, s[60:63], 0 offen offset:256
    buffer_load_ushort v247, v7, s[64:67], 0 offen offset:256
    s_lshl_b32 s3, s2, 2
    s_load_dword s82, s[78:79], s3
    s_mov_b32 s77, 0x3fb8aa3b
    s_mov_b32 s78, 0xffff0000
    s_mov_b32 s79, 0x3e22f983
    v_lshlrev_b32 v5, 3, v1
    v_cvt_f32_u32 v24, v5
    v_and_b32 v5, 7, v1
    v_lshrrev_b32 v6, 3, v1
    v_lshl_add_u32 v5, v6, 7, v5
    v_cvt_f32_u32 v25, v5
    v_lshrrev_b32 v5, 2, v1
    v_lshlrev_b32 v5, 7, v5
    v_and_b32 v6, 3, v1
    v_lshl_add_u32 v5, v6, 1, v5
    v_add_u32 v5, 0x100, v5
    v_subrev_u32 v6, 8, v1
    v_lshrrev_b32 v7, 1, v6
    v_lshlrev_b32 v7, 7, v7
    v_and_b32 v6, 1, v6
    v_lshl_add_u32 v7, v6, 2, v7
    v_add_u32 v7, 0x200, v7
    v_cmp_gt_u32 vcc, 8, v1
    s_nop 1
    v_cndmask_b32 v5, v7, v5, vcc
    v_cvt_f32_u32 v26, v5
    v_lshlrev_b32 v5, 7, v1
    v_add_u32 v5, 0x400, v5
    v_cvt_f32_u32 v27, v5
    v_mul_u32_u24 v28, 3200, v3
    v_add_u32 v28, 53248, v28
    v_and_b32 v5, 1, v2
    v_lshlrev_b32 v5, 2, v5
    v_lshrrev_b32 v6, 1, v2
    v_lshl_add_u32 v5, v6, 7, v5
    v_lshl_add_u32 v29, v1, 3, v5
    v_lshlrev_b32 v5, 6, v2
    v_lshl_add_u32 v6, v1, 2, v5
    v_add_u32 v6, 256, v6
    v_lshl_add_u32 v7, v1, 1, v5
    v_add_u32 v7, 256, v7
    v_cmp_gt_u32 vcc, 2, v2
    s_nop 1
    v_cndmask_b32 v30, v7, v6, vcc
    v_mov_b32 v6, 32
    v_cndmask_b32 v6, v6, 2, vcc
    v_add_u32 v31, v30, v6
    v_add_u32 v6, v5, v1
    v_add_u32 v32, 512, v6
    v_add_u32 v5, 0, v29
    v_lshrrev_b32 v6, 5, v5
    v_add_u32 v5, v5, v6
    v_lshl_add_u32 v50, v5, 2, v28
    v_add_u32 v5, 1, v29
    v_lshrrev_b32 v6, 5, v5
    v_add_u32 v5, v5, v6
    v_lshl_add_u32 v51, v5, 2, v28
    v_add_u32 v5, 2, v29
    v_lshrrev_b32 v6, 5, v5
    v_add_u32 v5, v5, v6
    v_lshl_add_u32 v52, v5, 2, v28
    v_add_u32 v5, 3, v29
    v_lshrrev_b32 v6, 5, v5
    v_add_u32 v5, v5, v6
    v_lshl_add_u32 v53, v5, 2, v28
    v_add_u32 v5, 0, v30
    v_lshrrev_b32 v6, 5, v5
    v_add_u32 v5, v5, v6
    v_lshl_add_u32 v54, v5, 2, v28
    v_add_u32 v5, 1, v30
    v_lshrrev_b32 v6, 5, v5
    v_add_u32 v5, v5, v6
    v_lshl_add_u32 v55, v5, 2, v28
    v_add_u32 v5, 0, v31
    v_lshrrev_b32 v6, 5, v5
    v_add_u32 v5, v5, v6
    v_lshl_add_u32 v56, v5, 2, v28
    v_add_u32 v5, 1, v31
    v_lshrrev_b32 v6, 5, v5
    v_add_u32 v5, v5, v6
    v_lshl_add_u32 v57, v5, 2, v28
    v_add_u32 v5, 0, v32
    v_lshrrev_b32 v6, 5, v5
    v_add_u32 v5, v5, v6
    v_lshl_add_u32 v58, v5, 2, v28
    v_add_u32 v5, 16, v32
    v_lshrrev_b32 v6, 5, v5
    v_add_u32 v5, v5, v6
    v_lshl_add_u32 v59, v5, 2, v28
    v_add_u32 v5, 32, v32
    v_lshrrev_b32 v6, 5, v5
    v_add_u32 v5, v5, v6
    v_lshl_add_u32 v60, v5, 2, v28
    v_add_u32 v5, 48, v32
    v_lshrrev_b32 v6, 5, v5
    v_add_u32 v5, v5, v6
    v_lshl_add_u32 v61, v5, 2, v28
    v_lshlrev_b32 v5, 3, v0
    v_sub_u32 v5, 0x7ff, v5
    s_movk_i32 s67, 0xbd80
    s_mov_b32 s64, 53248
    v_subrev_u32 v6, 0, v5
    v_subrev_u32 v7, 1, v5
    v_cvt_f32_u32 v72, v6
    v_cvt_f32_u32 v73, v7
    v_cvt_pk_bf16_f32 v72, v72, v73
    v_lshrrev_b32 v73, 16, v72
    v_and_b32 v72, 0xffff, v72
    v_add_u32 v72, s67, v72
    v_add_u32 v73, s67, v73
    v_cmp_gt_u32 vcc, 0x80, v6
    s_nop 1
    v_cndmask_b32 v72, v72, v6, vcc
    v_cmp_gt_u32 vcc, 0x80, v7
    s_nop 1
    v_cndmask_b32 v73, v73, v7, vcc
    v_lshrrev_b32 v6, 5, v72
    v_add_u32 v72, v72, v6
    v_lshrrev_b32 v7, 5, v73
    v_add_u32 v73, v73, v7
    v_lshl_add_u32 v100, v72, 2, s64
    v_lshl_add_u32 v101, v73, 2, s64
    v_subrev_u32 v6, 2, v5
    v_subrev_u32 v7, 3, v5
    v_cvt_f32_u32 v72, v6
    v_cvt_f32_u32 v73, v7
    v_cvt_pk_bf16_f32 v72, v72, v73
    v_lshrrev_b32 v73, 16, v72
    v_and_b32 v72, 0xffff, v72
    v_add_u32 v72, s67, v72
    v_add_u32 v73, s67, v73
    v_cmp_gt_u32 vcc, 0x80, v6
    s_nop 1
    v_cndmask_b32 v72, v72, v6, vcc
    v_cmp_gt_u32 vcc, 0x80, v7
    s_nop 1
    v_cndmask_b32 v73, v73, v7, vcc
    v_lshrrev_b32 v6, 5, v72
    v_add_u32 v72, v72, v6
    v_lshrrev_b32 v7, 5, v73
    v_add_u32 v73, v73, v7
    v_lshl_add_u32 v102, v72, 2, s64
    v_lshl_add_u32 v103, v73, 2, s64
    v_subrev_u32 v6, 4, v5
    v_subrev_u32 v7, 5, v5
    v_cvt_f32_u32 v72, v6
    v_cvt_f32_u32 v73, v7
    v_cvt_pk_bf16_f32 v72, v72, v73
    v_lshrrev_b32 v73, 16, v72
    v_and_b32 v72, 0xffff, v72
    v_add_u32 v72, s67, v72
    v_add_u32 v73, s67, v73
    v_cmp_gt_u32 vcc, 0x80, v6
    s_nop 1
    v_cndmask_b32 v72, v72, v6, vcc
    v_cmp_gt_u32 vcc, 0x80, v7
    s_nop 1
    v_cndmask_b32 v73, v73, v7, vcc
    v_lshrrev_b32 v6, 5, v72
    v_add_u32 v72, v72, v6
    v_lshrrev_b32 v7, 5, v73
    v_add_u32 v73, v73, v7
    v_lshl_add_u32 v104, v72, 2, s64
    v_lshl_add_u32 v105, v73, 2, s64
    v_subrev_u32 v6, 6, v5
    v_subrev_u32 v7, 7, v5
    v_cvt_f32_u32 v72, v6
    v_cvt_f32_u32 v73, v7
    v_cvt_pk_bf16_f32 v72, v72, v73
    v_lshrrev_b32 v73, 16, v72
    v_and_b32 v72, 0xffff, v72
    v_add_u32 v72, s67, v72
    v_add_u32 v73, s67, v73
    v_cmp_gt_u32 vcc, 0x80, v6
    s_nop 1
    v_cndmask_b32 v72, v72, v6, vcc
    v_cmp_gt_u32 vcc, 0x80, v7
    s_nop 1
    v_cndmask_b32 v73, v73, v7, vcc
    v_lshrrev_b32 v6, 5, v72
    v_add_u32 v72, v72, v6
    v_lshrrev_b32 v7, 5, v73
    v_add_u32 v73, v73, v7
    v_lshl_add_u32 v106, v72, 2, s64
    v_lshl_add_u32 v107, v73, 2, s64
    v_lshlrev_b32 v108, 4, v0
    v_add_u32 v108, 34816, v108
    v_mov_b32 v128, 0
    v_mov_b32 v129, 0
    v_mov_b32 v130, 0
    v_mov_b32 v131, 0
    v_bfe_u32 v5, v0, 5, 1
    v_mul_u32_u24 v5, 4608, v5
    v_and_b32 v6, 31, v0
    v_lshl_add_u32 v5, v6, 4, v5
    v_add_u32 v5, 38912, v5
    v_cmp_gt_u32 vcc, 64, v0
    s_nop 0
    s_and_saveexec_b64 s[64:65], vcc
    s_cbranch_execz MK_18
    ds_write_b128 v5, v[128:131]
MK_18:
    s_mov_b64 exec, s[64:65]
    s_waitcnt lgkmcnt(0)
    s_lshl_b32 s3, s82, 16
    v_mov_b32 v33, s3
    v_mul_f32 v33, s77, v33
    v_exp_f32 v33, v33
    s_nop 0
    v_cvt_pk_bf16_f32 v33, v33, v33
    v_and_b32 v33, s78, v33
    v_add_f32 v34, v33, v33
    v_mov_b32 v38, 0
    v_mov_b32 v39, 0
    v_mov_b32 v40, 0
    v_mov_b32 v41, 0
    v_mov_b32 v42, 0
    v_mov_b32 v43, 0
    v_mov_b32 v44, 0
    v_mov_b32 v45, 0
    v_mov_b32 v46, 0
    v_mov_b32 v47, 0
    v_mov_b32 v48, 0
    v_mov_b32 v49, 0
    s_waitcnt vmcnt(4)
    v_lshlrev_b32 v88, 16, v240
    v_lshlrev_b32 v89, 16, v241
    v_lshlrev_b32 v90, 16, v242
    v_lshlrev_b32 v91, 16, v243
    v_mul_f32 v88, s77, v88
    v_exp_f32 v88, v88
    v_mul_f32 v89, v89, v33
    v_mul_f32 v90, v90, v34
    v_cvt_pk_bf16_f32 v88, v88, v88
    v_and_b32 v88, s78, v88
    v_mul_f32 v91, v91, v34
    v_mul_f32 v88, v88, v33
    v_mul_f32 v89, s79, v89
    v_mul_f32 v88, s77, v88
    v_and_b32 v5, 31, v4
    v_lshlrev_b32 v5, 4, v5
    v_lshl_add_u32 v5, v3, 9, v5
    v_add_u32 v5, 66048, v5
    ds_write_b128 v5, v[88:91]
    v_lshlrev_b32 v6, 7, v2
    v_lshl_add_u32 v6, v3, 9, v6
    v_add_u32 v6, 66048, v6
    s_waitcnt lgkmcnt(0)
    ds_read_b128 v[200:203], v6 offset:0
    ds_read_b128 v[204:207], v6 offset:16
    ds_read_b128 v[208:211], v6 offset:32
    ds_read_b128 v[212:215], v6 offset:48
    ds_read_b128 v[216:219], v6 offset:64
    ds_read_b128 v[220:223], v6 offset:80
    ds_read_b128 v[224:227], v6 offset:96
    ds_read_b128 v[228:231], v6 offset:112
    s_waitcnt lgkmcnt(0)
    v_mul_f32 v136, -v200, v24
    v_mul_f32 v158, -v204, v24
    v_mul_f32 v140, v201, v24
    v_mul_f32 v162, v205, v24
    v_mul_f32 v137, -v200, v25
    v_mul_f32 v159, -v204, v25
    v_mul_f32 v141, v201, v25
    v_mul_f32 v163, v205, v25
    v_mul_f32 v138, -v200, v26
    v_mul_f32 v160, -v204, v26
    v_mul_f32 v142, v201, v26
    v_mul_f32 v164, v205, v26
    v_mul_f32 v139, -v200, v27
    v_mul_f32 v161, -v204, v27
    v_mul_f32 v143, v201, v27
    v_mul_f32 v165, v205, v27
    v_exp_f32 v136, v136
    v_exp_f32 v158, v158
    v_fract_f32 v140, v140
    v_fract_f32 v162, v162
    v_exp_f32 v137, v137
    v_exp_f32 v159, v159
    v_fract_f32 v141, v141
    v_fract_f32 v163, v163
    v_exp_f32 v138, v138
    v_exp_f32 v160, v160
    v_fract_f32 v142, v142
    v_fract_f32 v164, v164
    v_exp_f32 v139, v139
    v_exp_f32 v161, v161
    v_fract_f32 v143, v143
    v_fract_f32 v165, v165
    v_cos_f32 v144, v140
    v_cos_f32 v166, v162
    v_sin_f32 v148, v140
    v_sin_f32 v170, v162
    v_cos_f32 v145, v141
    v_cos_f32 v167, v163
    v_sin_f32 v149, v141
    v_sin_f32 v171, v163
    v_cos_f32 v146, v142
    v_cos_f32 v168, v164
    v_sin_f32 v150, v142
    v_sin_f32 v172, v164
    v_cos_f32 v147, v143
    v_cos_f32 v169, v165
    v_sin_f32 v151, v143
    v_sin_f32 v173, v165
    v_mul_f32 v144, v144, v136
    v_mul_f32 v166, v166, v158
    v_mul_f32 v148, v148, v136
    v_mul_f32 v170, v170, v158
    v_mul_f32 v145, v145, v137
    v_mul_f32 v167, v167, v159
    v_mul_f32 v149, v149, v137
    v_mul_f32 v171, v171, v159
    v_mul_f32 v146, v146, v138
    v_mul_f32 v168, v168, v160
    v_mul_f32 v150, v150, v138
    v_mul_f32 v172, v172, v160
    v_mul_f32 v147, v147, v139
    v_mul_f32 v169, v169, v161
    v_mul_f32 v151, v151, v139
    v_mul_f32 v173, v173, v161
    v_mul_f32 v152, v202, v144
    v_mul_f32 v174, v206, v166
    v_mul_f32 v153, -v202, v148
    v_mul_f32 v175, -v206, v170
    v_fma_f32 v152, -v203, v148, v152
    v_fma_f32 v174, -v207, v170, v174
    v_fma_f32 v153, -v203, v144, v153
    v_fma_f32 v175, -v207, v166, v175
    v_mul_f32 v180, -v208, v24
    v_mul_f32 v68, -v212, v24
    v_mul_f32 v184, v209, v24
    v_mul_f32 v72, v213, v24
    v_mul_f32 v181, -v208, v25
    v_mfma_f32_16x16x4_f32 v[38:41], v145, v152, v[38:41]
    v_mul_f32 v69, -v212, v25
    v_mul_f32 v185, v209, v25
    v_mul_f32 v73, v213, v25
    v_mul_f32 v182, -v208, v26
    v_mul_f32 v70, -v212, v26
    v_mul_f32 v186, v209, v26
    v_mul_f32 v74, v213, v26
    v_mul_f32 v183, -v208, v27
    v_mfma_f32_16x16x4_f32 v[42:45], v146, v152, v[42:45]
    v_mul_f32 v71, -v212, v27
    v_mul_f32 v187, v209, v27
    v_mul_f32 v75, v213, v27
    v_exp_f32 v180, v180
    v_exp_f32 v68, v68
    v_fract_f32 v184, v184
    v_fract_f32 v72, v72
    v_exp_f32 v181, v181
    v_mfma_f32_16x16x4_f32 v[46:49], v147, v152, v[46:49]
    v_exp_f32 v69, v69
    v_fract_f32 v185, v185
    v_fract_f32 v73, v73
    v_exp_f32 v182, v182
    v_exp_f32 v70, v70
    v_fract_f32 v186, v186
    v_fract_f32 v74, v74
    v_exp_f32 v183, v183
    v_mfma_f32_16x16x4_f32 v[38:41], v149, v153, v[38:41]
    v_exp_f32 v71, v71
    v_fract_f32 v187, v187
    v_fract_f32 v75, v75
    v_cos_f32 v188, v184
    v_cos_f32 v76, v72
    v_sin_f32 v192, v184
    v_sin_f32 v80, v72
    v_cos_f32 v189, v185
    v_mfma_f32_16x16x4_f32 v[42:45], v150, v153, v[42:45]
    v_cos_f32 v77, v73
    v_sin_f32 v193, v185
    v_sin_f32 v81, v73
    v_cos_f32 v190, v186
    v_cos_f32 v78, v74
    v_sin_f32 v194, v186
    v_sin_f32 v82, v74
    v_cos_f32 v191, v187
    v_mfma_f32_16x16x4_f32 v[46:49], v151, v153, v[46:49]
    v_cos_f32 v79, v75
    v_sin_f32 v195, v187
    v_sin_f32 v83, v75
    v_mul_f32 v188, v188, v180
    v_mul_f32 v76, v76, v68
    v_mul_f32 v192, v192, v180
    v_mul_f32 v80, v80, v68
    v_mul_f32 v189, v189, v181
    v_mfma_f32_16x16x4_f32 v[38:41], v167, v174, v[38:41]
    v_mul_f32 v77, v77, v69
    v_mul_f32 v193, v193, v181
    v_mul_f32 v81, v81, v69
    v_mul_f32 v190, v190, v182
    v_mul_f32 v78, v78, v70
    v_mul_f32 v194, v194, v182
    v_mul_f32 v82, v82, v70
    v_mul_f32 v191, v191, v183
    v_mfma_f32_16x16x4_f32 v[42:45], v168, v174, v[42:45]
    v_mul_f32 v79, v79, v71
    v_mul_f32 v195, v195, v183
    v_mul_f32 v83, v83, v71
    v_mul_f32 v196, v210, v188
    v_mul_f32 v84, v214, v76
    v_mul_f32 v197, -v210, v192
    v_mul_f32 v85, -v214, v80
    v_fma_f32 v196, -v211, v192, v196
    v_mfma_f32_16x16x4_f32 v[46:49], v169, v174, v[46:49]
    v_fma_f32 v84, -v215, v80, v84
    v_fma_f32 v197, -v211, v188, v197
    v_fma_f32 v85, -v215, v76, v85
    v_mfma_f32_16x16x4_f32 v[38:41], v171, v175, v[38:41]
    v_mfma_f32_16x16x4_f32 v[42:45], v172, v175, v[42:45]
    v_mfma_f32_16x16x4_f32 v[46:49], v173, v175, v[46:49]
    v_mul_f32 v136, -v216, v24
    v_mul_f32 v158, -v220, v24
    v_mul_f32 v140, v217, v24
    v_mul_f32 v162, v221, v24
    v_mul_f32 v137, -v216, v25
    v_mfma_f32_16x16x4_f32 v[38:41], v189, v196, v[38:41]
    v_mul_f32 v159, -v220, v25
    v_mul_f32 v141, v217, v25
    v_mul_f32 v163, v221, v25
    v_mul_f32 v138, -v216, v26
    v_mul_f32 v160, -v220, v26
    v_mul_f32 v142, v217, v26
    v_mul_f32 v164, v221, v26
    v_mul_f32 v139, -v216, v27
    v_mfma_f32_16x16x4_f32 v[42:45], v190, v196, v[42:45]
    v_mul_f32 v161, -v220, v27
    v_mul_f32 v143, v217, v27
    v_mul_f32 v165, v221, v27
    v_exp_f32 v136, v136
    v_exp_f32 v158, v158
    v_fract_f32 v140, v140
    v_fract_f32 v162, v162
    v_exp_f32 v137, v137
    v_mfma_f32_16x16x4_f32 v[46:49], v191, v196, v[46:49]
    v_exp_f32 v159, v159
    v_fract_f32 v141, v141
    v_fract_f32 v163, v163
    v_exp_f32 v138, v138
    v_exp_f32 v160, v160
    v_fract_f32 v142, v142
    v_fract_f32 v164, v164
    v_exp_f32 v139, v139
    v_mfma_f32_16x16x4_f32 v[38:41], v193, v197, v[38:41]
    v_exp_f32 v161, v161
    v_fract_f32 v143, v143
    v_fract_f32 v165, v165
    v_cos_f32 v144, v140
    v_cos_f32 v166, v162
    v_sin_f32 v148, v140
    v_sin_f32 v170, v162
    v_cos_f32 v145, v141
    v_mfma_f32_16x16x4_f32 v[42:45], v194, v197, v[42:45]
    v_cos_f32 v167, v163
    v_sin_f32 v149, v141
    v_sin_f32 v171, v163
    v_cos_f32 v146, v142
    v_cos_f32 v168, v164
    v_sin_f32 v150, v142
    v_sin_f32 v172, v164
    v_cos_f32 v147, v143
    v_mfma_f32_16x16x4_f32 v[46:49], v195, v197, v[46:49]
    v_cos_f32 v169, v165
    v_sin_f32 v151, v143
    v_sin_f32 v173, v165
    v_mul_f32 v144, v144, v136
    v_mul_f32 v166, v166, v158
    v_mul_f32 v148, v148, v136
    v_mul_f32 v170, v170, v158
    v_mul_f32 v145, v145, v137
    v_mfma_f32_16x16x4_f32 v[38:41], v77, v84, v[38:41]
    v_mul_f32 v167, v167, v159
    v_mul_f32 v149, v149, v137
    v_mul_f32 v171, v171, v159
    v_mul_f32 v146, v146, v138
    v_mul_f32 v168, v168, v160
    v_mul_f32 v150, v150, v138
    v_mul_f32 v172, v172, v160
    v_mul_f32 v147, v147, v139
    v_mfma_f32_16x16x4_f32 v[42:45], v78, v84, v[42:45]
    v_mul_f32 v169, v169, v161
    v_mul_f32 v151, v151, v139
    v_mul_f32 v173, v173, v161
    v_mul_f32 v152, v218, v144
    v_mul_f32 v174, v222, v166
    v_mul_f32 v153, -v218, v148
    v_mul_f32 v175, -v222, v170
    v_fma_f32 v152, -v219, v148, v152
    v_mfma_f32_16x16x4_f32 v[46:49], v79, v84, v[46:49]
    v_fma_f32 v174, -v223, v170, v174
    v_fma_f32 v153, -v219, v144, v153
    v_fma_f32 v175, -v223, v166, v175
    v_mfma_f32_16x16x4_f32 v[38:41], v81, v85, v[38:41]
    v_mfma_f32_16x16x4_f32 v[42:45], v82, v85, v[42:45]
    v_mfma_f32_16x16x4_f32 v[46:49], v83, v85, v[46:49]
    s_and_b32 s64, s2, 7
    s_lshr_b32 s65, s2, 3
    s_and_b32 s70, s64, 1
    s_lshl_b32 s70, s70, 3
    s_and_b32 s66, s65, 7
    s_add_u32 s70, s70, s66
    s_lshr_b32 s71, s64, 1
    s_lshl_b32 s71, s71, 2
    s_lshr_b32 s66, s65, 3
    s_add_u32 s71, s71, s66
    v_mul_u32_u24 v120, 0x5556, v0
    v_lshrrev_b32 v120, 16, v120
    v_mul_u32_u24 v121, 3, v120
    v_sub_u32 v121, v0, v121
    s_and_b32 s64, s70, 7
    s_mul_i32 s64, s64, 52
    s_add_u32 s64, s64, 96
    v_add_u32 v120, s64, v120
    v_mul_u32_u24 v120, 3584, v120
    v_mul_u32_u24 v121, 110, v121
    v_and_b32 v121, 0xfffffffc, v121
    s_mul_i32 s64, s71, 224
    v_add3_u32 v120, v120, v121, s64
    v_cmp_gt_u32 vcc, 156, v0
    s_nop 0
    s_and_saveexec_b64 s[64:65], vcc
    s_cbranch_execz MK_19
    buffer_load_dword v124, v120, s[28:31], 0 offen
    buffer_load_dword v125, v120, s[32:35], 0 offen
MK_19:
    s_mov_b64 exec, s[64:65]
    v_mul_f32 v180, -v224, v24
    v_mul_f32 v68, -v228, v24
    v_mul_f32 v184, v225, v24
    v_mul_f32 v72, v229, v24
    v_mul_f32 v181, -v224, v25
    v_mfma_f32_16x16x4_f32 v[38:41], v145, v152, v[38:41]
    v_mul_f32 v69, -v228, v25
    v_mul_f32 v185, v225, v25
    v_mul_f32 v73, v229, v25
    v_mul_f32 v182, -v224, v26
    v_mul_f32 v70, -v228, v26
    v_mul_f32 v186, v225, v26
    v_mul_f32 v74, v229, v26
    v_mul_f32 v183, -v224, v27
    v_mfma_f32_16x16x4_f32 v[42:45], v146, v152, v[42:45]
    v_mul_f32 v71, -v228, v27
    v_mul_f32 v187, v225, v27
    v_mul_f32 v75, v229, v27
    v_exp_f32 v180, v180
    v_exp_f32 v68, v68
    v_fract_f32 v184, v184
    v_fract_f32 v72, v72
    v_exp_f32 v181, v181
    v_mfma_f32_16x16x4_f32 v[46:49], v147, v152, v[46:49]
    v_exp_f32 v69, v69
    v_fract_f32 v185, v185
    v_fract_f32 v73, v73
    v_exp_f32 v182, v182
    v_exp_f32 v70, v70
    v_fract_f32 v186, v186
    v_fract_f32 v74, v74
    v_exp_f32 v183, v183
    v_mfma_f32_16x16x4_f32 v[38:41], v149, v153, v[38:41]
    v_exp_f32 v71, v71
    v_fract_f32 v187, v187
    v_fract_f32 v75, v75
    v_cos_f32 v188, v184
    v_cos_f32 v76, v72
    v_sin_f32 v192, v184
    v_sin_f32 v80, v72
    v_cos_f32 v189, v185
    v_mfma_f32_16x16x4_f32 v[42:45], v150, v153, v[42:45]
    v_cos_f32 v77, v73
    v_sin_f32 v193, v185
    v_sin_f32 v81, v73
    v_cos_f32 v190, v186
    v_cos_f32 v78, v74
    v_sin_f32 v194, v186
    v_sin_f32 v82, v74
    v_cos_f32 v191, v187
    v_mfma_f32_16x16x4_f32 v[46:49], v151, v153, v[46:49]
    v_cos_f32 v79, v75
    v_sin_f32 v195, v187
    v_sin_f32 v83, v75
    v_mul_f32 v188, v188, v180
    v_mul_f32 v76, v76, v68
    v_mul_f32 v192, v192, v180
    v_mul_f32 v80, v80, v68
    v_mul_f32 v189, v189, v181
    v_mfma_f32_16x16x4_f32 v[38:41], v167, v174, v[38:41]
    v_mul_f32 v77, v77, v69
    v_mul_f32 v193, v193, v181
    v_mul_f32 v81, v81, v69
    v_mul_f32 v190, v190, v182
    v_mul_f32 v78, v78, v70
    v_mul_f32 v194, v194, v182
    v_mul_f32 v82, v82, v70
    v_mul_f32 v191, v191, v183
    v_mfma_f32_16x16x4_f32 v[42:45], v168, v174, v[42:45]
    v_mul_f32 v79, v79, v71
    v_mul_f32 v195, v195, v183
    v_mul_f32 v83, v83, v71
    v_mul_f32 v196, v226, v188
    v_mul_f32 v84, v230, v76
    v_mul_f32 v197, -v226, v192
    v_mul_f32 v85, -v230, v80
    v_fma_f32 v196, -v227, v192, v196
    v_mfma_f32_16x16x4_f32 v[46:49], v169, v174, v[46:49]
    v_fma_f32 v84, -v231, v80, v84
    v_fma_f32 v197, -v227, v188, v197
    v_fma_f32 v85, -v231, v76, v85
    v_mfma_f32_16x16x4_f32 v[38:41], v171, v175, v[38:41]
    v_mfma_f32_16x16x4_f32 v[42:45], v172, v175, v[42:45]
    v_mfma_f32_16x16x4_f32 v[46:49], v173, v175, v[46:49]
    v_mfma_f32_16x16x4_f32 v[38:41], v189, v196, v[38:41]
    v_mfma_f32_16x16x4_f32 v[42:45], v190, v196, v[42:45]
    v_mfma_f32_16x16x4_f32 v[46:49], v191, v196, v[46:49]
    v_mfma_f32_16x16x4_f32 v[38:41], v193, v197, v[38:41]
    v_mfma_f32_16x16x4_f32 v[42:45], v194, v197, v[42:45]
    v_mfma_f32_16x16x4_f32 v[46:49], v195, v197, v[46:49]
    v_mfma_f32_16x16x4_f32 v[38:41], v77, v84, v[38:41]
    v_mfma_f32_16x16x4_f32 v[42:45], v78, v84, v[42:45]
    v_mfma_f32_16x16x4_f32 v[46:49], v79, v84, v[46:49]
    v_mfma_f32_16x16x4_f32 v[38:41], v81, v85, v[38:41]
    v_mfma_f32_16x16x4_f32 v[42:45], v82, v85, v[42:45]
    v_mfma_f32_16x16x4_f32 v[46:49], v83, v85, v[46:49]
    s_nop 7
    ds_write_b32 v50, v38
    ds_write_b32 v51, v39
    ds_write_b32 v52, v40
    ds_write_b32 v53, v41
    ds_write_b32 v54, v42
    ds_write_b32 v55, v43
    ds_write_b32 v56, v44
    ds_write_b32 v57, v45
    ds_write_b32 v58, v46
    ds_write_b32 v59, v47
    ds_write_b32 v60, v48
    ds_write_b32 v61, v49
    s_waitcnt lgkmcnt(0)
    s_barrier
    ds_read_b32 v132, v100 offset:0
    ds_read_b32 v133, v100 offset:3200
    ds_read_b32 v134, v100 offset:6400
    ds_read_b32 v135, v100 offset:9600
    ds_read_b32 v136, v101 offset:0
    ds_read_b32 v137, v101 offset:3200
    ds_read_b32 v138, v101 offset:6400
    ds_read_b32 v139, v101 offset:9600
    ds_read_b32 v140, v102 offset:0
    ds_read_b32 v141, v102 offset:3200
    ds_read_b32 v142, v102 offset:6400
    ds_read_b32 v143, v102 offset:9600
    ds_read_b32 v144, v103 offset:0
    ds_read_b32 v145, v103 offset:3200
    ds_read_b32 v146, v103 offset:6400
    ds_read_b32 v147, v103 offset:9600
    ds_read_b32 v148, v104 offset:0
    ds_read_b32 v149, v104 offset:3200
    ds_read_b32 v150, v104 offset:6400
    ds_read_b32 v151, v104 offset:9600
    ds_read_b32 v152, v105 offset:0
    ds_read_b32 v153, v105 offset:3200
    ds_read_b32 v154, v105 offset:6400
    ds_read_b32 v155, v105 offset:9600
    ds_read_b32 v156, v106 offset:0
    ds_read_b32 v157, v106 offset:3200
    ds_read_b32 v158, v106 offset:6400
    ds_read_b32 v159, v106 offset:9600
    ds_read_b32 v160, v107 offset:0
    ds_read_b32 v161, v107 offset:3200
    ds_read_b32 v162, v107 offset:6400
    ds_read_b32 v163, v107 offset:9600
    s_waitcnt lgkmcnt(0)
    v_add_f32 v132, v132, v133
    v_add_f32 v134, v134, v135
    v_add_f32 v132, v132, v134
    v_add_f32 v136, v136, v137
    v_add_f32 v138, v138, v139
    v_add_f32 v136, v136, v138
    v_add_f32 v140, v140, v141
    v_add_f32 v142, v142, v143
    v_add_f32 v140, v140, v142
    v_add_f32 v144, v144, v145
    v_add_f32 v146, v146, v147
    v_add_f32 v144, v144, v146
    v_add_f32 v148, v148, v149
    v_add_f32 v150, v150, v151
    v_add_f32 v148, v148, v150
    v_add_f32 v152, v152, v153
    v_add_f32 v154, v154, v155
    v_add_f32 v152, v152, v154
    v_add_f32 v156, v156, v157
    v_add_f32 v158, v158, v159
    v_add_f32 v156, v156, v158
    v_add_f32 v160, v160, v161
    v_add_f32 v162, v162, v163
    v_add_f32 v160, v160, v162
    v_cvt_pk_bf16_f32 v110, v132, v136
    v_lshlrev_b32 v118, 16, v110
    v_and_b32 v119, s78, v110
    v_sub_f32 v118, v132, v118
    v_sub_f32 v119, v136, v119
    v_cvt_pk_bf16_f32 v114, v118, v119
    v_cvt_pk_bf16_f32 v111, v140, v144
    v_lshlrev_b32 v118, 16, v111
    v_and_b32 v119, s78, v111
    v_sub_f32 v118, v140, v118
    v_sub_f32 v119, v144, v119
    v_cvt_pk_bf16_f32 v115, v118, v119
    v_cvt_pk_bf16_f32 v112, v148, v152
    v_lshlrev_b32 v118, 16, v112
    v_and_b32 v119, s78, v112
    v_sub_f32 v118, v148, v118
    v_sub_f32 v119, v152, v119
    v_cvt_pk_bf16_f32 v116, v118, v119
    v_cvt_pk_bf16_f32 v113, v156, v160
    v_lshlrev_b32 v118, 16, v113
    v_and_b32 v119, s78, v113
    v_sub_f32 v118, v156, v118
    v_sub_f32 v119, v160, v119
    v_cvt_pk_bf16_f32 v117, v118, v119
    ds_write_b128 v108, v[110:113] offset:0
    ds_write_b128 v108, v[114:117] offset:4608
    s_waitcnt lgkmcnt(0)
    s_barrier
    s_mov_b32 s77, 0x3fb8aa3b
    s_mov_b32 s78, 0xffff0000
    s_mov_b32 s79, 0x3e22f983
    v_mov_b32 v128, 0
    v_mov_b32 v129, 0
    v_mov_b32 v130, 0
    v_mov_b32 v131, 0
    v_bfe_u32 v5, v0, 5, 1
    v_mul_u32_u24 v5, 4608, v5
    v_and_b32 v6, 31, v0
    v_lshl_add_u32 v5, v6, 4, v5
    v_add_u32 v5, 48128, v5
    v_cmp_gt_u32 vcc, 64, v0
    s_nop 0
    s_and_saveexec_b64 s[64:65], vcc
    s_cbranch_execz MK_20
    ds_write_b128 v5, v[128:131]
MK_20:
    s_mov_b64 exec, s[64:65]
    s_waitcnt lgkmcnt(0)
    s_and_b32 s3, s82, 0xffff0000
    v_mov_b32 v33, s3
    v_mul_f32 v33, s77, v33
    v_exp_f32 v33, v33
    s_nop 0
    v_cvt_pk_bf16_f32 v33, v33, v33
    v_and_b32 v33, s78, v33
    v_add_f32 v34, v33, v33
    v_mov_b32 v38, 0
    v_mov_b32 v39, 0
    v_mov_b32 v40, 0
    v_mov_b32 v41, 0
    v_mov_b32 v42, 0
    v_mov_b32 v43, 0
    v_mov_b32 v44, 0
    v_mov_b32 v45, 0
    v_mov_b32 v46, 0
    v_mov_b32 v47, 0
    v_mov_b32 v48, 0
    v_mov_b32 v49, 0
    s_waitcnt vmcnt(0)
    v_lshlrev_b32 v88, 16, v244
    v_lshlrev_b32 v89, 16, v245
    v_lshlrev_b32 v90, 16, v246
    v_lshlrev_b32 v91, 16, v247
    v_mul_f32 v88, s77, v88
    v_exp_f32 v88, v88
    v_mul_f32 v89, v89, v33
    v_mul_f32 v90, v90, v34
    v_cvt_pk_bf16_f32 v88, v88, v88
    v_and_b32 v88, s78, v88
    v_mul_f32 v91, v91, v34
    v_mul_f32 v88, v88, v33
    v_mul_f32 v89, s79, v89
    v_mul_f32 v88, s77, v88
    v_and_b32 v5, 31, v4
    v_lshlrev_b32 v5, 4, v5
    v_lshl_add_u32 v5, v3, 9, v5
    v_add_u32 v5, 66048, v5
    ds_write_b128 v5, v[88:91]
    v_lshlrev_b32 v6, 7, v2
    v_lshl_add_u32 v6, v3, 9, v6
    v_add_u32 v6, 66048, v6
    s_waitcnt lgkmcnt(0)
    ds_read_b128 v[200:203], v6 offset:0
    ds_read_b128 v[204:207], v6 offset:16
    ds_read_b128 v[208:211], v6 offset:32
    ds_read_b128 v[212:215], v6 offset:48
    ds_read_b128 v[216:219], v6 offset:64
    ds_read_b128 v[220:223], v6 offset:80
    ds_read_b128 v[224:227], v6 offset:96
    ds_read_b128 v[228:231], v6 offset:112
    s_waitcnt lgkmcnt(0)
    v_mov_b32 v122, 0
    s_cmp_lg_u32 s68, 0
    s_cbranch_scc1 TI_21
    buffer_load_dword v123, v122, s[48:51], 0 offen sc1
TI_21:
    v_mul_f32 v136, -v200, v24
    v_mul_f32 v158, -v204, v24
    v_mul_f32 v140, v201, v24
    v_mul_f32 v162, v205, v24
    v_mul_f32 v137, -v200, v25
    v_mul_f32 v159, -v204, v25
    v_mul_f32 v141, v201, v25
    v_mul_f32 v163, v205, v25
    v_mul_f32 v138, -v200, v26
    v_mul_f32 v160, -v204, v26
    v_mul_f32 v142, v201, v26
    v_mul_f32 v164, v205, v26
    v_mul_f32 v139, -v200, v27
    v_mul_f32 v161, -v204, v27
    v_mul_f32 v143, v201, v27
    v_mul_f32 v165, v205, v27
    v_exp_f32 v136, v136
    v_exp_f32 v158, v158
    v_fract_f32 v140, v140
    v_fract_f32 v162, v162
    v_exp_f32 v137, v137
    v_exp_f32 v159, v159
    v_fract_f32 v141, v141
    v_fract_f32 v163, v163
    v_exp_f32 v138, v138
    v_exp_f32 v160, v160
    v_fract_f32 v142, v142
    v_fract_f32 v164, v164
    v_exp_f32 v139, v139
    v_exp_f32 v161, v161
    v_fract_f32 v143, v143
    v_fract_f32 v165, v165
    v_cos_f32 v144, v140
    v_cos_f32 v166, v162
    v_sin_f32 v148, v140
    v_sin_f32 v170, v162
    v_cos_f32 v145, v141
    v_cos_f32 v167, v163
    v_sin_f32 v149, v141
    v_sin_f32 v171, v163
    v_cos_f32 v146, v142
    v_cos_f32 v168, v164
    v_sin_f32 v150, v142
    v_sin_f32 v172, v164
    v_cos_f32 v147, v143
    v_cos_f32 v169, v165
    v_sin_f32 v151, v143
    v_sin_f32 v173, v165
    v_mul_f32 v144, v144, v136
    v_mul_f32 v166, v166, v158
    v_mul_f32 v148, v148, v136
    v_mul_f32 v170, v170, v158
    v_mul_f32 v145, v145, v137
    v_mul_f32 v167, v167, v159
    v_mul_f32 v149, v149, v137
    v_mul_f32 v171, v171, v159
    v_mul_f32 v146, v146, v138
    v_mul_f32 v168, v168, v160
    v_mul_f32 v150, v150, v138
    v_mul_f32 v172, v172, v160
    v_mul_f32 v147, v147, v139
    v_mul_f32 v169, v169, v161
    v_mul_f32 v151, v151, v139
    v_mul_f32 v173, v173, v161
    v_mul_f32 v152, v202, v144
    v_mul_f32 v174, v206, v166
    v_mul_f32 v153, -v202, v148
    v_mul_f32 v175, -v206, v170
    v_fma_f32 v152, -v203, v148, v152
    v_fma_f32 v174, -v207, v170, v174
    v_fma_f32 v153, -v203, v144, v153
    v_fma_f32 v175, -v207, v166, v175
    v_mul_f32 v180, -v208, v24
    v_mul_f32 v68, -v212, v24
    v_mul_f32 v184, v209, v24
    v_mul_f32 v72, v213, v24
    v_mul_f32 v181, -v208, v25
    v_mfma_f32_16x16x4_f32 v[38:41], v145, v152, v[38:41]
    v_mul_f32 v69, -v212, v25
    v_mul_f32 v185, v209, v25
    v_mul_f32 v73, v213, v25
    v_mul_f32 v182, -v208, v26
    v_mul_f32 v70, -v212, v26
    v_mul_f32 v186, v209, v26
    v_mul_f32 v74, v213, v26
    v_mul_f32 v183, -v208, v27
    v_mfma_f32_16x16x4_f32 v[42:45], v146, v152, v[42:45]
    v_mul_f32 v71, -v212, v27
    v_mul_f32 v187, v209, v27
    v_mul_f32 v75, v213, v27
    v_exp_f32 v180, v180
    v_exp_f32 v68, v68
    v_fract_f32 v184, v184
    v_fract_f32 v72, v72
    v_exp_f32 v181, v181
    v_mfma_f32_16x16x4_f32 v[46:49], v147, v152, v[46:49]
    v_exp_f32 v69, v69
    v_fract_f32 v185, v185
    v_fract_f32 v73, v73
    v_exp_f32 v182, v182
    v_exp_f32 v70, v70
    v_fract_f32 v186, v186
    v_fract_f32 v74, v74
    v_exp_f32 v183, v183
    v_mfma_f32_16x16x4_f32 v[38:41], v149, v153, v[38:41]
    v_exp_f32 v71, v71
    v_fract_f32 v187, v187
    v_fract_f32 v75, v75
    v_cos_f32 v188, v184
    v_cos_f32 v76, v72
    v_sin_f32 v192, v184
    v_sin_f32 v80, v72
    v_cos_f32 v189, v185
    v_mfma_f32_16x16x4_f32 v[42:45], v150, v153, v[42:45]
    v_cos_f32 v77, v73
    v_sin_f32 v193, v185
    v_sin_f32 v81, v73
    v_cos_f32 v190, v186
    v_cos_f32 v78, v74
    v_sin_f32 v194, v186
    v_sin_f32 v82, v74
    v_cos_f32 v191, v187
    v_mfma_f32_16x16x4_f32 v[46:49], v151, v153, v[46:49]
    v_cos_f32 v79, v75
    v_sin_f32 v195, v187
    v_sin_f32 v83, v75
    v_mul_f32 v188, v188, v180
    v_mul_f32 v76, v76, v68
    v_mul_f32 v192, v192, v180
    v_mul_f32 v80, v80, v68
    v_mul_f32 v189, v189, v181
    v_mfma_f32_16x16x4_f32 v[38:41], v167, v174, v[38:41]
    v_mul_f32 v77, v77, v69
    v_mul_f32 v193, v193, v181
    v_mul_f32 v81, v81, v69
    v_mul_f32 v190, v190, v182
    v_mul_f32 v78, v78, v70
    v_mul_f32 v194, v194, v182
    v_mul_f32 v82, v82, v70
    v_mul_f32 v191, v191, v183
    v_mfma_f32_16x16x4_f32 v[42:45], v168, v174, v[42:45]
    v_mul_f32 v79, v79, v71
    v_mul_f32 v195, v195, v183
    v_mul_f32 v83, v83, v71
    v_mul_f32 v196, v210, v188
    v_mul_f32 v84, v214, v76
    v_mul_f32 v197, -v210, v192
    v_mul_f32 v85, -v214, v80
    v_fma_f32 v196, -v211, v192, v196
    v_mfma_f32_16x16x4_f32 v[46:49], v169, v174, v[46:49]
    v_fma_f32 v84, -v215, v80, v84
    v_fma_f32 v197, -v211, v188, v197
    v_fma_f32 v85, -v215, v76, v85
    v_mfma_f32_16x16x4_f32 v[38:41], v171, v175, v[38:41]
    v_mfma_f32_16x16x4_f32 v[42:45], v172, v175, v[42:45]
    v_mfma_f32_16x16x4_f32 v[46:49], v173, v175, v[46:49]
    v_mul_f32 v136, -v216, v24
    v_mul_f32 v158, -v220, v24
    v_mul_f32 v140, v217, v24
    v_mul_f32 v162, v221, v24
    v_mul_f32 v137, -v216, v25
    v_mfma_f32_16x16x4_f32 v[38:41], v189, v196, v[38:41]
    v_mul_f32 v159, -v220, v25
    v_mul_f32 v141, v217, v25
    v_mul_f32 v163, v221, v25
    v_mul_f32 v138, -v216, v26
    v_mul_f32 v160, -v220, v26
    v_mul_f32 v142, v217, v26
    v_mul_f32 v164, v221, v26
    v_mul_f32 v139, -v216, v27
    v_mfma_f32_16x16x4_f32 v[42:45], v190, v196, v[42:45]
    v_mul_f32 v161, -v220, v27
    v_mul_f32 v143, v217, v27
    v_mul_f32 v165, v221, v27
    v_exp_f32 v136, v136
    v_exp_f32 v158, v158
    v_fract_f32 v140, v140
    v_fract_f32 v162, v162
    v_exp_f32 v137, v137
    v_mfma_f32_16x16x4_f32 v[46:49], v191, v196, v[46:49]
    v_exp_f32 v159, v159
    v_fract_f32 v141, v141
    v_fract_f32 v163, v163
    v_exp_f32 v138, v138
    v_exp_f32 v160, v160
    v_fract_f32 v142, v142
    v_fract_f32 v164, v164
    v_exp_f32 v139, v139
    v_mfma_f32_16x16x4_f32 v[38:41], v193, v197, v[38:41]
    v_exp_f32 v161, v161
    v_fract_f32 v143, v143
    v_fract_f32 v165, v165
    v_cos_f32 v144, v140
    v_cos_f32 v166, v162
    v_sin_f32 v148, v140
    v_sin_f32 v170, v162
    v_cos_f32 v145, v141
    v_mfma_f32_16x16x4_f32 v[42:45], v194, v197, v[42:45]
    v_cos_f32 v167, v163
    v_sin_f32 v149, v141
    v_sin_f32 v171, v163
    v_cos_f32 v146, v142
    v_cos_f32 v168, v164
    v_sin_f32 v150, v142
    v_sin_f32 v172, v164
    v_cos_f32 v147, v143
    v_mfma_f32_16x16x4_f32 v[46:49], v195, v197, v[46:49]
    v_cos_f32 v169, v165
    v_sin_f32 v151, v143
    v_sin_f32 v173, v165
    v_mul_f32 v144, v144, v136
    v_mul_f32 v166, v166, v158
    v_mul_f32 v148, v148, v136
    v_mul_f32 v170, v170, v158
    v_mul_f32 v145, v145, v137
    v_mfma_f32_16x16x4_f32 v[38:41], v77, v84, v[38:41]
    v_mul_f32 v167, v167, v159
    v_mul_f32 v149, v149, v137
    v_mul_f32 v171, v171, v159
    v_mul_f32 v146, v146, v138
    v_mul_f32 v168, v168, v160
    v_mul_f32 v150, v150, v138
    v_mul_f32 v172, v172, v160
    v_mul_f32 v147, v147, v139
    v_mfma_f32_16x16x4_f32 v[42:45], v78, v84, v[42:45]
    v_mul_f32 v169, v169, v161
    v_mul_f32 v151, v151, v139
    v_mul_f32 v173, v173, v161
    v_mul_f32 v152, v218, v144
    v_mul_f32 v174, v222, v166
    v_mul_f32 v153, -v218, v148
    v_mul_f32 v175, -v222, v170
    v_fma_f32 v152, -v219, v148, v152
    v_mfma_f32_16x16x4_f32 v[46:49], v79, v84, v[46:49]
    v_fma_f32 v174, -v223, v170, v174
    v_fma_f32 v153, -v219, v144, v153
    v_fma_f32 v175, -v223, v166, v175
    v_mfma_f32_16x16x4_f32 v[38:41], v81, v85, v[38:41]
    v_mfma_f32_16x16x4_f32 v[42:45], v82, v85, v[42:45]
    v_mfma_f32_16x16x4_f32 v[46:49], v83, v85, v[46:49]
    v_mul_f32 v180, -v224, v24
    v_mul_f32 v68, -v228, v24
    v_mul_f32 v184, v225, v24
    v_mul_f32 v72, v229, v24
    v_mul_f32 v181, -v224, v25
    v_mfma_f32_16x16x4_f32 v[38:41], v145, v152, v[38:41]
    v_mul_f32 v69, -v228, v25
    v_mul_f32 v185, v225, v25
    v_mul_f32 v73, v229, v25
    v_mul_f32 v182, -v224, v26
    v_mul_f32 v70, -v228, v26
    v_mul_f32 v186, v225, v26
    v_mul_f32 v74, v229, v26
    v_mul_f32 v183, -v224, v27
    v_mfma_f32_16x16x4_f32 v[42:45], v146, v152, v[42:45]
    v_mul_f32 v71, -v228, v27
    v_mul_f32 v187, v225, v27
    v_mul_f32 v75, v229, v27
    v_exp_f32 v180, v180
    v_exp_f32 v68, v68
    v_fract_f32 v184, v184
    v_fract_f32 v72, v72
    v_exp_f32 v181, v181
    v_mfma_f32_16x16x4_f32 v[46:49], v147, v152, v[46:49]
    v_exp_f32 v69, v69
    v_fract_f32 v185, v185
    v_fract_f32 v73, v73
    v_exp_f32 v182, v182
    v_exp_f32 v70, v70
    v_fract_f32 v186, v186
    v_fract_f32 v74, v74
    v_exp_f32 v183, v183
    v_mfma_f32_16x16x4_f32 v[38:41], v149, v153, v[38:41]
    v_exp_f32 v71, v71
    v_fract_f32 v187, v187
    v_fract_f32 v75, v75
    v_cos_f32 v188, v184
    v_cos_f32 v76, v72
    v_sin_f32 v192, v184
    v_sin_f32 v80, v72
    v_cos_f32 v189, v185
    v_mfma_f32_16x16x4_f32 v[42:45], v150, v153, v[42:45]
    v_cos_f32 v77, v73
    v_sin_f32 v193, v185
    v_sin_f32 v81, v73
    v_cos_f32 v190, v186
    v_cos_f32 v78, v74
    v_sin_f32 v194, v186
    v_sin_f32 v82, v74
    v_cos_f32 v191, v187
    v_mfma_f32_16x16x4_f32 v[46:49], v151, v153, v[46:49]
    v_cos_f32 v79, v75
    v_sin_f32 v195, v187
    v_sin_f32 v83, v75
    v_mul_f32 v188, v188, v180
    v_mul_f32 v76, v76, v68
    v_mul_f32 v192, v192, v180
    v_mul_f32 v80, v80, v68
    v_mul_f32 v189, v189, v181
    v_mfma_f32_16x16x4_f32 v[38:41], v167, v174, v[38:41]
    v_mul_f32 v77, v77, v69
    v_mul_f32 v193, v193, v181
    v_mul_f32 v81, v81, v69
    v_mul_f32 v190, v190, v182
    v_mul_f32 v78, v78, v70
    v_mul_f32 v194, v194, v182
    v_mul_f32 v82, v82, v70
    v_mul_f32 v191, v191, v183
    v_mfma_f32_16x16x4_f32 v[42:45], v168, v174, v[42:45]
    v_mul_f32 v79, v79, v71
    v_mul_f32 v195, v195, v183
    v_mul_f32 v83, v83, v71
    v_mul_f32 v196, v226, v188
    v_mul_f32 v84, v230, v76
    v_mul_f32 v197, -v226, v192
    v_mul_f32 v85, -v230, v80
    v_fma_f32 v196, -v227, v192, v196
    v_mfma_f32_16x16x4_f32 v[46:49], v169, v174, v[46:49]
    v_fma_f32 v84, -v231, v80, v84
    v_fma_f32 v197, -v227, v188, v197
    v_fma_f32 v85, -v231, v76, v85
    v_mfma_f32_16x16x4_f32 v[38:41], v171, v175, v[38:41]
    v_mfma_f32_16x16x4_f32 v[42:45], v172, v175, v[42:45]
    v_mfma_f32_16x16x4_f32 v[46:49], v173, v175, v[46:49]
    v_mfma_f32_16x16x4_f32 v[38:41], v189, v196, v[38:41]
    v_mfma_f32_16x16x4_f32 v[42:45], v190, v196, v[42:45]
    v_mfma_f32_16x16x4_f32 v[46:49], v191, v196, v[46:49]
    v_mfma_f32_16x16x4_f32 v[38:41], v193, v197, v[38:41]
    v_mfma_f32_16x16x4_f32 v[42:45], v194, v197, v[42:45]
    v_mfma_f32_16x16x4_f32 v[46:49], v195, v197, v[46:49]
    v_mfma_f32_16x16x4_f32 v[38:41], v77, v84, v[38:41]
    v_mfma_f32_16x16x4_f32 v[42:45], v78, v84, v[42:45]
    v_mfma_f32_16x16x4_f32 v[46:49], v79, v84, v[46:49]
    v_mfma_f32_16x16x4_f32 v[38:41], v81, v85, v[38:41]
    v_mfma_f32_16x16x4_f32 v[42:45], v82, v85, v[42:45]
    v_mfma_f32_16x16x4_f32 v[46:49], v83, v85, v[46:49]
    s_nop 7
    ds_write_b32 v50, v38
    ds_write_b32 v51, v39
    ds_write_b32 v52, v40
    ds_write_b32 v53, v41
    ds_write_b32 v54, v42
    ds_write_b32 v55, v43
    ds_write_b32 v56, v44
    ds_write_b32 v57, v45
    ds_write_b32 v58, v46
    ds_write_b32 v59, v47
    ds_write_b32 v60, v48
    ds_write_b32 v61, v49
    s_waitcnt lgkmcnt(0)
    s_barrier
    ds_read_b32 v132, v100 offset:0
    ds_read_b32 v133, v100 offset:3200
    ds_read_b32 v134, v100 offset:6400
    ds_read_b32 v135, v100 offset:9600
    ds_read_b32 v136, v101 offset:0
    ds_read_b32 v137, v101 offset:3200
    ds_read_b32 v138, v101 offset:6400
    ds_read_b32 v139, v101 offset:9600
    ds_read_b32 v140, v102 offset:0
    ds_read_b32 v141, v102 offset:3200
    ds_read_b32 v142, v102 offset:6400
    ds_read_b32 v143, v102 offset:9600
    ds_read_b32 v144, v103 offset:0
    ds_read_b32 v145, v103 offset:3200
    ds_read_b32 v146, v103 offset:6400
    ds_read_b32 v147, v103 offset:9600
    ds_read_b32 v148, v104 offset:0
    ds_read_b32 v149, v104 offset:3200
    ds_read_b32 v150, v104 offset:6400
    ds_read_b32 v151, v104 offset:9600
    ds_read_b32 v152, v105 offset:0
    ds_read_b32 v153, v105 offset:3200
    ds_read_b32 v154, v105 offset:6400
    ds_read_b32 v155, v105 offset:9600
    ds_read_b32 v156, v106 offset:0
    ds_read_b32 v157, v106 offset:3200
    ds_read_b32 v158, v106 offset:6400
    ds_read_b32 v159, v106 offset:9600
    ds_read_b32 v160, v107 offset:0
    ds_read_b32 v161, v107 offset:3200
    ds_read_b32 v162, v107 offset:6400
    ds_read_b32 v163, v107 offset:9600
    s_waitcnt lgkmcnt(0)
    v_add_f32 v132, v132, v133
    v_add_f32 v134, v134, v135
    v_add_f32 v132, v132, v134
    v_add_f32 v136, v136, v137
    v_add_f32 v138, v138, v139
    v_add_f32 v136, v136, v138
    v_add_f32 v140, v140, v141
    v_add_f32 v142, v142, v143
    v_add_f32 v140, v140, v142
    v_add_f32 v144, v144, v145
    v_add_f32 v146, v146, v147
    v_add_f32 v144, v144, v146
    v_add_f32 v148, v148, v149
    v_add_f32 v150, v150, v151
    v_add_f32 v148, v148, v150
    v_add_f32 v152, v152, v153
    v_add_f32 v154, v154, v155
    v_add_f32 v152, v152, v154
    v_add_f32 v156, v156, v157
    v_add_f32 v158, v158, v159
    v_add_f32 v156, v156, v158
    v_add_f32 v160, v160, v161
    v_add_f32 v162, v162, v163
    v_add_f32 v160, v160, v162
    v_cvt_pk_bf16_f32 v110, v132, v136
    v_lshlrev_b32 v118, 16, v110
    v_and_b32 v119, s78, v110
    v_sub_f32 v118, v132, v118
    v_sub_f32 v119, v136, v119
    v_cvt_pk_bf16_f32 v114, v118, v119
    v_cvt_pk_bf16_f32 v111, v140, v144
    v_lshlrev_b32 v118, 16, v111
    v_and_b32 v119, s78, v111
    v_sub_f32 v118, v140, v118
    v_sub_f32 v119, v144, v119
    v_cvt_pk_bf16_f32 v115, v118, v119
    v_cvt_pk_bf16_f32 v112, v148, v152
    v_lshlrev_b32 v118, 16, v112
    v_and_b32 v119, s78, v112
    v_sub_f32 v118, v148, v118
    v_sub_f32 v119, v152, v119
    v_cvt_pk_bf16_f32 v116, v118, v119
    v_cvt_pk_bf16_f32 v113, v156, v160
    v_lshlrev_b32 v118, 16, v113
    v_and_b32 v119, s78, v113
    v_sub_f32 v118, v156, v118
    v_sub_f32 v119, v160, v119
    v_cvt_pk_bf16_f32 v117, v118, v119
    ds_write_b128 v108, v[110:113] offset:9216
    ds_write_b128 v108, v[114:117] offset:13824
    s_waitcnt lgkmcnt(0)
    s_barrier
    s_cmp_lg_u32 s68, 0
    s_cbranch_scc1 TGE_23
    s_waitcnt vmcnt(0)
    s_mov_b32 s66, 0
TG_22:
    v_readfirstlane_b32 s83, v123
    s_add_u32 s66, s66, 1
    s_cmp_lg_u32 s83, 0
    s_cbranch_scc1 TGE_23
    s_cmp_gt_u32 s66, 0x40000
    s_cbranch_scc1 TGE_23
    s_sleep 8
    buffer_load_dword v123, v122, s[48:51], 0 offen sc1
    s_waitcnt vmcnt(0)
    s_branch TG_22
TGE_23:
    s_and_b32 s64, s2, 7
    s_lshl_b32 s64, s64, 10
    s_add_u32 s64, s64, 24576
    v_lshlrev_b32 v16, 4, v4
    v_add_u32 v16, s64, v16
    s_cmp_lg_u32 s68, 0
    s_cbranch_scc1 PI_24
    buffer_load_dwordx4 v[20:23], v16, s[4:7], 0 offen sc1
PI_24:
    s_cmp_lg_u32 s68, 0
    s_cbranch_scc1 POLLE_26
    s_waitcnt vmcnt(0)
    s_mov_b32 s66, 0
POLL_25:
    v_xor_b32 v20, s83, v20
    v_xor_b32 v21, s83, v21
    v_xor_b32 v22, s83, v22
    v_xor_b32 v23, s83, v23
    v_or3_b32 v20, v20, v21, v22
    v_or_b32 v20, v20, v23
    v_cmp_ne_u32 vcc, 0, v20
    s_add_u32 s66, s66, 1
    s_nop 1
    s_cmp_eq_u64 vcc, 0
    s_cbranch_scc1 POLLE_26
    s_cmp_gt_u32 s66, 0x40000
    s_cbranch_scc1 POLLE_26
    s_sleep 12
    buffer_load_dwordx4 v[20:23], v16, s[4:7], 0 offen sc1
    s_waitcnt vmcnt(0)
    s_branch POLL_25
POLLE_26:
    s_barrier
    s_mul_i32 s3, s2, 8320
    s_movk_i32 s66, 4160
    v_lshlrev_b32 v5, 4, v0
    v_add_u32 v6, s3, v5
    v_add_u32 v7, 4096, v6
    v_cmp_gt_u32 vcc, 2, v0
    s_nop 0
    s_and_saveexec_b64 s[64:65], vcc
    s_cbranch_execz MK_27
    buffer_load_dwordx4 v[176:179], v7, s[16:19], 0 offen offset:0 sc1
    buffer_load_dwordx4 v[180:183], v7, s[16:19], 0 offen offset:16 sc1
    buffer_load_dwordx4 v[248:251], v7, s[16:19], s66 offen offset:0 sc1
    buffer_load_dwordx4 v[252:255], v7, s[16:19], s66 offen offset:16 sc1
MK_27:
    s_mov_b64 exec, s[64:65]
    buffer_load_dwordx4 v[168:171], v6, s[16:19], 0 offen offset:0 sc1
    buffer_load_dwordx4 v[172:175], v6, s[16:19], 0 offen offset:16 sc1
    buffer_load_dwordx4 v[240:243], v6, s[16:19], s66 offen offset:0 sc1
    buffer_load_dwordx4 v[244:247], v6, s[16:19], s66 offen offset:16 sc1
    s_lshr_b32 s64, s2, 6
    s_mul_i32 s64, s64, 448
    s_lshl_b32 s64, s64, 10
    s_lshr_b32 s65, s2, 3
    s_and_b32 s65, s65, 7
    s_lshl_b32 s65, s65, 7
    s_add_u32 s64, s64, s65
    v_lshlrev_b32 v121, 10, v0
    v_add_u32 v121, s64, v121
    s_mov_b32 s66, 0x40000
    buffer_load_dword v13, v121, s[36:39], 0 offen
    v_cmp_gt_u32 vcc, 192, v0
    s_nop 0
    s_and_saveexec_b64 s[64:65], vcc
    s_cbranch_execz MK_28
    buffer_load_dword v14, v121, s[36:39], s66 offen
MK_28:
    s_mov_b64 exec, s[64:65]
    v_lshlrev_b32 v5, 4, v0
    v_add_u32 v10, 4096, v5
    v_add_u32 v6, 1, v1
    v_and_b32 v7, 7, v6
    v_mul_u32_u24 v8, 4352, v7
    s_mov_b32 s67, 3414709264
    v_lshlrev_b32 v9, 2, v7
    v_lshrrev_b32 v9, v9, s67
    v_and_b32 v9, 15, v9
    v_lshl_add_u32 v8, v9, 4, v8
    v_and_b32 v6, 0x18, v6
    v_lshl_add_u32 v6, v2, 3, v6
    v_lshl_add_u32 v8, v6, 1, v8
    s_lshl_b32 s64, s68, 7
    v_add_u32 v11, s64, v8
    v_lshlrev_b32 v6, 5, v1
    v_lshlrev_b32 v7, 4, v2
    v_sub_u32 v6, v7, v6
    s_add_u32 s64, s64, 35296
    v_add_u32 v12, s64, v6
    s_waitcnt vmcnt(2)
    ds_write_b128 v5, v[168:171] offset:0
    v_alignbit_b32 v20, v169, v168, 16
    v_alignbit_b32 v21, v170, v169, 16
    v_alignbit_b32 v22, v171, v170, 16
    v_alignbit_b32 v23, v172, v171, 16
    ds_write_b128 v5, v[20:23] offset:4368
    v_mov_b32 v24, v169
    v_mov_b32 v25, v170
    v_mov_b32 v26, v171
    v_mov_b32 v27, v172
    ds_write_b128 v5, v[24:27] offset:8768
    v_alignbit_b32 v28, v170, v169, 16
    v_alignbit_b32 v29, v171, v170, 16
    v_alignbit_b32 v30, v172, v171, 16
    v_alignbit_b32 v31, v173, v172, 16
    ds_write_b128 v5, v[28:31] offset:13136
    ds_write_b128 v5, v[170:173] offset:17536
    v_alignbit_b32 v36, v171, v170, 16
    v_alignbit_b32 v37, v172, v171, 16
    v_alignbit_b32 v38, v173, v172, 16
    v_alignbit_b32 v39, v174, v173, 16
    ds_write_b128 v5, v[36:39] offset:21888
    v_mov_b32 v40, v171
    v_mov_b32 v41, v172
    v_mov_b32 v42, v173
    v_mov_b32 v43, v174
    ds_write_b128 v5, v[40:43] offset:26288
    v_alignbit_b32 v44, v172, v171, 16
    v_alignbit_b32 v45, v173, v172, 16
    v_alignbit_b32 v46, v174, v173, 16
    v_alignbit_b32 v47, v175, v174, 16
    ds_write_b128 v5, v[44:47] offset:30656
    v_cmp_gt_u32 vcc, 2, v0
    s_nop 0
    s_and_saveexec_b64 s[64:65], vcc
    s_cbranch_execz MK_29
    ds_write_b128 v10, v[176:179] offset:0
    v_alignbit_b32 v20, v177, v176, 16
    v_alignbit_b32 v21, v178, v177, 16
    v_alignbit_b32 v22, v179, v178, 16
    v_alignbit_b32 v23, v180, v179, 16
    ds_write_b128 v10, v[20:23] offset:4368
    v_mov_b32 v24, v177
    v_mov_b32 v25, v178
    v_mov_b32 v26, v179
    v_mov_b32 v27, v180
    ds_write_b128 v10, v[24:27] offset:8768
    v_alignbit_b32 v28, v178, v177, 16
    v_alignbit_b32 v29, v179, v178, 16
    v_alignbit_b32 v30, v180, v179, 16
    v_alignbit_b32 v31, v181, v180, 16
    ds_write_b128 v10, v[28:31] offset:13136
    ds_write_b128 v10, v[178:181] offset:17536
    v_alignbit_b32 v36, v179, v178, 16
    v_alignbit_b32 v37, v180, v179, 16
    v_alignbit_b32 v38, v181, v180, 16
    v_alignbit_b32 v39, v182, v181, 16
    ds_write_b128 v10, v[36:39] offset:21888
    v_mov_b32 v40, v179
    v_mov_b32 v41, v180
    v_mov_b32 v42, v181
    v_mov_b32 v43, v182
    ds_write_b128 v10, v[40:43] offset:26288
    v_alignbit_b32 v44, v180, v179, 16
    v_alignbit_b32 v45, v181, v180, 16
    v_alignbit_b32 v46, v182, v181, 16
    v_alignbit_b32 v47, v183, v182, 16
    ds_write_b128 v10, v[44:47] offset:30656
MK_29:
    s_mov_b64 exec, s[64:65]
    s_waitcnt lgkmcnt(0)
    s_barrier
    v_mov_b32 v208, 0
    v_mov_b32 v209, 0
    v_mov_b32 v210, 0
    v_mov_b32 v211, 0
    v_mov_b32 v212, 0
    v_mov_b32 v213, 0
    v_mov_b32 v214, 0
    v_mov_b32 v215, 0
    v_mov_b32 v216, 0
    v_mov_b32 v217, 0
    v_mov_b32 v218, 0
    v_mov_b32 v219, 0
    v_mov_b32 v220, 0
    v_mov_b32 v221, 0
    v_mov_b32 v222, 0
    v_mov_b32 v223, 0
    v_mov_b32 v224, 0
    v_mov_b32 v225, 0
    v_mov_b32 v226, 0
    v_mov_b32 v227, 0
    v_mov_b32 v228, 0
    v_mov_b32 v229, 0
    v_mov_b32 v230, 0
    v_mov_b32 v231, 0
    v_mov_b32 v232, 0
    v_mov_b32 v233, 0
    v_mov_b32 v234, 0
    v_mov_b32 v235, 0
    v_mov_b32 v236, 0
    v_mov_b32 v237, 0
    v_mov_b32 v238, 0
    v_mov_b32 v239, 0
    ds_read_b128 v[16:19], v11 offset:0
    ds_read_b128 v[48:51], v12 offset:3584
    ds_read_b128 v[80:83], v12 offset:8192
    ds_read_b128 v[20:23], v11 offset:512
    ds_read_b128 v[52:55], v12 offset:3072
    ds_read_b128 v[84:87], v12 offset:7680
    ds_read_b128 v[24:27], v11 offset:1024
    ds_read_b128 v[56:59], v12 offset:2560
    ds_read_b128 v[88:91], v12 offset:7168
    ds_read_b128 v[28:31], v11 offset:1536
    ds_read_b128 v[60:63], v12 offset:2048
    ds_read_b128 v[92:95], v12 offset:6656
    ds_read_b128 v[32:35], v11 offset:2048
    ds_read_b128 v[64:67], v12 offset:1536
    ds_read_b128 v[96:99], v12 offset:6144
    ds_read_b128 v[36:39], v11 offset:2560
    ds_read_b128 v[68:71], v12 offset:1024
    ds_read_b128 v[100:103], v12 offset:5632
    ds_read_b128 v[40:43], v11 offset:3072
    ds_read_b128 v[72:75], v12 offset:512
    ds_read_b128 v[104:107], v12 offset:5120
    ds_read_b128 v[44:47], v11 offset:3584
    ds_read_b128 v[76:79], v12 offset:0
    ds_read_b128 v[108:111], v12 offset:4608
    s_waitcnt lgkmcnt(0)
    v_mfma_f32_16x16x32_bf16 v[208:211], v[16:19], v[48:51], v[208:211]
    v_mfma_f32_16x16x32_bf16 v[208:211], v[16:19], v[80:83], v[208:211]
    v_mfma_f32_16x16x32_bf16 v[212:215], v[16:19], v[52:55], v[212:215]
    v_mfma_f32_16x16x32_bf16 v[212:215], v[16:19], v[84:87], v[212:215]
    v_mfma_f32_16x16x32_bf16 v[212:215], v[20:23], v[48:51], v[212:215]
    v_mfma_f32_16x16x32_bf16 v[212:215], v[20:23], v[80:83], v[212:215]
    v_mfma_f32_16x16x32_bf16 v[216:219], v[16:19], v[56:59], v[216:219]
    v_mfma_f32_16x16x32_bf16 v[216:219], v[16:19], v[88:91], v[216:219]
    v_mfma_f32_16x16x32_bf16 v[216:219], v[20:23], v[52:55], v[216:219]
    v_mfma_f32_16x16x32_bf16 v[216:219], v[20:23], v[84:87], v[216:219]
    ds_read_b128 v[112:115], v11 offset:64
    v_mfma_f32_16x16x32_bf16 v[216:219], v[24:27], v[48:51], v[216:219]
    v_mfma_f32_16x16x32_bf16 v[216:219], v[24:27], v[80:83], v[216:219]
    ds_read_b128 v[144:147], v12 offset:3648
    v_mfma_f32_16x16x32_bf16 v[220:223], v[16:19], v[60:63], v[220:223]
    v_mfma_f32_16x16x32_bf16 v[220:223], v[16:19], v[92:95], v[220:223]
    ds_read_b128 v[176:179], v12 offset:8256
    v_mfma_f32_16x16x32_bf16 v[220:223], v[20:23], v[56:59], v[220:223]
    v_mfma_f32_16x16x32_bf16 v[220:223], v[20:23], v[88:91], v[220:223]
    ds_read_b128 v[116:119], v11 offset:576
    v_mfma_f32_16x16x32_bf16 v[220:223], v[24:27], v[52:55], v[220:223]
    v_mfma_f32_16x16x32_bf16 v[220:223], v[24:27], v[84:87], v[220:223]
    ds_read_b128 v[148:151], v12 offset:3136
    v_mfma_f32_16x16x32_bf16 v[220:223], v[28:31], v[48:51], v[220:223]
    v_mfma_f32_16x16x32_bf16 v[220:223], v[28:31], v[80:83], v[220:223]
    ds_read_b128 v[180:183], v12 offset:7744
    v_mfma_f32_16x16x32_bf16 v[224:227], v[16:19], v[64:67], v[224:227]
    v_mfma_f32_16x16x32_bf16 v[224:227], v[16:19], v[96:99], v[224:227]
    ds_read_b128 v[120:123], v11 offset:1088
    v_mfma_f32_16x16x32_bf16 v[224:227], v[20:23], v[60:63], v[224:227]
    v_mfma_f32_16x16x32_bf16 v[224:227], v[20:23], v[92:95], v[224:227]
    ds_read_b128 v[152:155], v12 offset:2624
    v_mfma_f32_16x16x32_bf16 v[224:227], v[24:27], v[56:59], v[224:227]
    v_mfma_f32_16x16x32_bf16 v[224:227], v[24:27], v[88:91], v[224:227]
    ds_read_b128 v[184:187], v12 offset:7232
    v_mfma_f32_16x16x32_bf16 v[224:227], v[28:31], v[52:55], v[224:227]
    v_mfma_f32_16x16x32_bf16 v[224:227], v[28:31], v[84:87], v[224:227]
    ds_read_b128 v[124:127], v11 offset:1600
    v_mfma_f32_16x16x32_bf16 v[224:227], v[32:35], v[48:51], v[224:227]
    v_mfma_f32_16x16x32_bf16 v[224:227], v[32:35], v[80:83], v[224:227]
    ds_read_b128 v[156:159], v12 offset:2112
    v_mfma_f32_16x16x32_bf16 v[228:231], v[16:19], v[68:71], v[228:231]
    v_mfma_f32_16x16x32_bf16 v[228:231], v[16:19], v[100:103], v[228:231]
    ds_read_b128 v[188:191], v12 offset:6720
    v_mfma_f32_16x16x32_bf16 v[228:231], v[20:23], v[64:67], v[228:231]
    v_mfma_f32_16x16x32_bf16 v[228:231], v[20:23], v[96:99], v[228:231]
    ds_read_b128 v[128:131], v11 offset:2112
    v_mfma_f32_16x16x32_bf16 v[228:231], v[24:27], v[60:63], v[228:231]
    v_mfma_f32_16x16x32_bf16 v[228:231], v[24:27], v[92:95], v[228:231]
    ds_read_b128 v[160:163], v12 offset:1600
    v_mfma_f32_16x16x32_bf16 v[228:231], v[28:31], v[56:59], v[228:231]
    v_mfma_f32_16x16x32_bf16 v[228:231], v[28:31], v[88:91], v[228:231]
    ds_read_b128 v[192:195], v12 offset:6208
    v_mfma_f32_16x16x32_bf16 v[228:231], v[32:35], v[52:55], v[228:231]
    v_mfma_f32_16x16x32_bf16 v[228:231], v[32:35], v[84:87], v[228:231]
    ds_read_b128 v[132:135], v11 offset:2624
    v_mfma_f32_16x16x32_bf16 v[228:231], v[36:39], v[48:51], v[228:231]
    v_mfma_f32_16x16x32_bf16 v[228:231], v[36:39], v[80:83], v[228:231]
    ds_read_b128 v[164:167], v12 offset:1088
    v_mfma_f32_16x16x32_bf16 v[232:235], v[16:19], v[72:75], v[232:235]
    v_mfma_f32_16x16x32_bf16 v[232:235], v[16:19], v[104:107], v[232:235]
    ds_read_b128 v[196:199], v12 offset:5696
    v_mfma_f32_16x16x32_bf16 v[232:235], v[20:23], v[68:71], v[232:235]
    v_mfma_f32_16x16x32_bf16 v[232:235], v[20:23], v[100:103], v[232:235]
    ds_read_b128 v[136:139], v11 offset:3136
    v_mfma_f32_16x16x32_bf16 v[232:235], v[24:27], v[64:67], v[232:235]
    v_mfma_f32_16x16x32_bf16 v[232:235], v[24:27], v[96:99], v[232:235]
    ds_read_b128 v[168:171], v12 offset:576
    v_mfma_f32_16x16x32_bf16 v[232:235], v[28:31], v[60:63], v[232:235]
    v_mfma_f32_16x16x32_bf16 v[232:235], v[28:31], v[92:95], v[232:235]
    ds_read_b128 v[200:203], v12 offset:5184
    v_mfma_f32_16x16x32_bf16 v[232:235], v[32:35], v[56:59], v[232:235]
    v_mfma_f32_16x16x32_bf16 v[232:235], v[32:35], v[88:91], v[232:235]
    ds_read_b128 v[140:143], v11 offset:3648
    v_mfma_f32_16x16x32_bf16 v[232:235], v[36:39], v[52:55], v[232:235]
    v_mfma_f32_16x16x32_bf16 v[232:235], v[36:39], v[84:87], v[232:235]
    ds_read_b128 v[172:175], v12 offset:64
    v_mfma_f32_16x16x32_bf16 v[232:235], v[40:43], v[48:51], v[232:235]
    v_mfma_f32_16x16x32_bf16 v[232:235], v[40:43], v[80:83], v[232:235]
    ds_read_b128 v[204:207], v12 offset:4672
    v_mfma_f32_16x16x32_bf16 v[236:239], v[16:19], v[76:79], v[236:239]
    v_mfma_f32_16x16x32_bf16 v[236:239], v[16:19], v[108:111], v[236:239]
    v_mfma_f32_16x16x32_bf16 v[236:239], v[20:23], v[72:75], v[236:239]
    v_mfma_f32_16x16x32_bf16 v[236:239], v[20:23], v[104:107], v[236:239]
    v_mfma_f32_16x16x32_bf16 v[236:239], v[24:27], v[68:71], v[236:239]
    v_mfma_f32_16x16x32_bf16 v[236:239], v[24:27], v[100:103], v[236:239]
    v_mfma_f32_16x16x32_bf16 v[236:239], v[28:31], v[64:67], v[236:239]
    v_mfma_f32_16x16x32_bf16 v[236:239], v[28:31], v[96:99], v[236:239]
    v_mfma_f32_16x16x32_bf16 v[236:239], v[32:35], v[60:63], v[236:239]
    v_mfma_f32_16x16x32_bf16 v[236:239], v[32:35], v[92:95], v[236:239]
    v_mfma_f32_16x16x32_bf16 v[236:239], v[36:39], v[56:59], v[236:239]
    v_mfma_f32_16x16x32_bf16 v[236:239], v[36:39], v[88:91], v[236:239]
    v_mfma_f32_16x16x32_bf16 v[236:239], v[40:43], v[52:55], v[236:239]
    v_mfma_f32_16x16x32_bf16 v[236:239], v[40:43], v[84:87], v[236:239]
    v_mfma_f32_16x16x32_bf16 v[236:239], v[44:47], v[48:51], v[236:239]
    v_mfma_f32_16x16x32_bf16 v[236:239], v[44:47], v[80:83], v[236:239]
    s_waitcnt lgkmcnt(0)
    v_mfma_f32_16x16x32_bf16 v[208:211], v[112:115], v[144:147], v[208:211]
    v_mfma_f32_16x16x32_bf16 v[208:211], v[112:115], v[176:179], v[208:211]
    v_mfma_f32_16x16x32_bf16 v[212:215], v[112:115], v[148:151], v[212:215]
    v_mfma_f32_16x16x32_bf16 v[212:215], v[112:115], v[180:183], v[212:215]
    v_mfma_f32_16x16x32_bf16 v[212:215], v[116:119], v[144:147], v[212:215]
    v_mfma_f32_16x16x32_bf16 v[212:215], v[116:119], v[176:179], v[212:215]
    v_mfma_f32_16x16x32_bf16 v[216:219], v[112:115], v[152:155], v[216:219]
    v_mfma_f32_16x16x32_bf16 v[216:219], v[112:115], v[184:187], v[216:219]
    v_mfma_f32_16x16x32_bf16 v[216:219], v[116:119], v[148:151], v[216:219]
    v_mfma_f32_16x16x32_bf16 v[216:219], v[116:119], v[180:183], v[216:219]
    v_mfma_f32_16x16x32_bf16 v[216:219], v[120:123], v[144:147], v[216:219]
    v_mfma_f32_16x16x32_bf16 v[216:219], v[120:123], v[176:179], v[216:219]
    v_mfma_f32_16x16x32_bf16 v[220:223], v[112:115], v[156:159], v[220:223]
    v_mfma_f32_16x16x32_bf16 v[220:223], v[112:115], v[188:191], v[220:223]
    v_mfma_f32_16x16x32_bf16 v[220:223], v[116:119], v[152:155], v[220:223]
    v_mfma_f32_16x16x32_bf16 v[220:223], v[116:119], v[184:187], v[220:223]
    v_mfma_f32_16x16x32_bf16 v[220:223], v[120:123], v[148:151], v[220:223]
    v_mfma_f32_16x16x32_bf16 v[220:223], v[120:123], v[180:183], v[220:223]
    v_mfma_f32_16x16x32_bf16 v[220:223], v[124:127], v[144:147], v[220:223]
    v_mfma_f32_16x16x32_bf16 v[220:223], v[124:127], v[176:179], v[220:223]
    v_mfma_f32_16x16x32_bf16 v[224:227], v[112:115], v[160:163], v[224:227]
    v_mfma_f32_16x16x32_bf16 v[224:227], v[112:115], v[192:195], v[224:227]
    v_mfma_f32_16x16x32_bf16 v[224:227], v[116:119], v[156:159], v[224:227]
    v_mfma_f32_16x16x32_bf16 v[224:227], v[116:119], v[188:191], v[224:227]
    v_mfma_f32_16x16x32_bf16 v[224:227], v[120:123], v[152:155], v[224:227]
    v_mfma_f32_16x16x32_bf16 v[224:227], v[120:123], v[184:187], v[224:227]
    v_mfma_f32_16x16x32_bf16 v[224:227], v[124:127], v[148:151], v[224:227]
    v_mfma_f32_16x16x32_bf16 v[224:227], v[124:127], v[180:183], v[224:227]
    v_mfma_f32_16x16x32_bf16 v[224:227], v[128:131], v[144:147], v[224:227]
    v_mfma_f32_16x16x32_bf16 v[224:227], v[128:131], v[176:179], v[224:227]
    v_mfma_f32_16x16x32_bf16 v[228:231], v[112:115], v[164:167], v[228:231]
    v_mfma_f32_16x16x32_bf16 v[228:231], v[112:115], v[196:199], v[228:231]
    v_mfma_f32_16x16x32_bf16 v[228:231], v[116:119], v[160:163], v[228:231]
    v_mfma_f32_16x16x32_bf16 v[228:231], v[116:119], v[192:195], v[228:231]
    v_mfma_f32_16x16x32_bf16 v[228:231], v[120:123], v[156:159], v[228:231]
    v_mfma_f32_16x16x32_bf16 v[228:231], v[120:123], v[188:191], v[228:231]
    v_mfma_f32_16x16x32_bf16 v[228:231], v[124:127], v[152:155], v[228:231]
    v_mfma_f32_16x16x32_bf16 v[228:231], v[124:127], v[184:187], v[228:231]
    v_mfma_f32_16x16x32_bf16 v[228:231], v[128:131], v[148:151], v[228:231]
    v_mfma_f32_16x16x32_bf16 v[228:231], v[128:131], v[180:183], v[228:231]
    v_mfma_f32_16x16x32_bf16 v[228:231], v[132:135], v[144:147], v[228:231]
    v_mfma_f32_16x16x32_bf16 v[228:231], v[132:135], v[176:179], v[228:231]
    v_mfma_f32_16x16x32_bf16 v[232:235], v[112:115], v[168:171], v[232:235]
    v_mfma_f32_16x16x32_bf16 v[232:235], v[112:115], v[200:203], v[232:235]
    v_mfma_f32_16x16x32_bf16 v[232:235], v[116:119], v[164:167], v[232:235]
    v_mfma_f32_16x16x32_bf16 v[232:235], v[116:119], v[196:199], v[232:235]
    v_mfma_f32_16x16x32_bf16 v[232:235], v[120:123], v[160:163], v[232:235]
    v_mfma_f32_16x16x32_bf16 v[232:235], v[120:123], v[192:195], v[232:235]
    v_mfma_f32_16x16x32_bf16 v[232:235], v[124:127], v[156:159], v[232:235]
    v_mfma_f32_16x16x32_bf16 v[232:235], v[124:127], v[188:191], v[232:235]
    v_mfma_f32_16x16x32_bf16 v[232:235], v[128:131], v[152:155], v[232:235]
    v_mfma_f32_16x16x32_bf16 v[232:235], v[128:131], v[184:187], v[232:235]
    v_mfma_f32_16x16x32_bf16 v[232:235], v[132:135], v[148:151], v[232:235]
    v_mfma_f32_16x16x32_bf16 v[232:235], v[132:135], v[180:183], v[232:235]
    v_mfma_f32_16x16x32_bf16 v[232:235], v[136:139], v[144:147], v[232:235]
    v_mfma_f32_16x16x32_bf16 v[232:235], v[136:139], v[176:179], v[232:235]
    v_mfma_f32_16x16x32_bf16 v[236:239], v[112:115], v[172:175], v[236:239]
    v_mfma_f32_16x16x32_bf16 v[236:239], v[112:115], v[204:207], v[236:239]
    v_mfma_f32_16x16x32_bf16 v[236:239], v[116:119], v[168:171], v[236:239]
    v_mfma_f32_16x16x32_bf16 v[236:239], v[116:119], v[200:203], v[236:239]
    v_mfma_f32_16x16x32_bf16 v[236:239], v[120:123], v[164:167], v[236:239]
    v_mfma_f32_16x16x32_bf16 v[236:239], v[120:123], v[196:199], v[236:239]
    v_mfma_f32_16x16x32_bf16 v[236:239], v[124:127], v[160:163], v[236:239]
    v_mfma_f32_16x16x32_bf16 v[236:239], v[124:127], v[192:195], v[236:239]
    v_mfma_f32_16x16x32_bf16 v[236:239], v[128:131], v[156:159], v[236:239]
    v_mfma_f32_16x16x32_bf16 v[236:239], v[128:131], v[188:191], v[236:239]
    v_mfma_f32_16x16x32_bf16 v[236:239], v[132:135], v[152:155], v[236:239]
    v_mfma_f32_16x16x32_bf16 v[236:239], v[132:135], v[184:187], v[236:239]
    v_mfma_f32_16x16x32_bf16 v[236:239], v[136:139], v[148:151], v[236:239]
    v_mfma_f32_16x16x32_bf16 v[236:239], v[136:139], v[180:183], v[236:239]
    v_mfma_f32_16x16x32_bf16 v[236:239], v[140:143], v[144:147], v[236:239]
    v_mfma_f32_16x16x32_bf16 v[236:239], v[140:143], v[176:179], v[236:239]
    v_lshlrev_b32 v5, 4, v4
    s_mul_i32 s64, s68, 6144
    s_add_u32 s64, s64, 53248
    v_add_u32 v6, s64, v5
    s_nop 7
    s_cmp_lg_u32 s68, 0
    s_cbranch_scc1 CXW_31
    ds_write_b128 v6, v[216:219] offset:0
    ds_write_b128 v6, v[220:223] offset:1024
    ds_write_b128 v6, v[224:227] offset:2048
    ds_write_b128 v6, v[228:231] offset:3072
    ds_write_b128 v6, v[232:235] offset:4096
    ds_write_b128 v6, v[236:239] offset:5120
    v_mov_b32 v16, v208
    v_mov_b32 v17, v209
    v_mov_b32 v18, v210
    v_mov_b32 v19, v211
    v_mov_b32 v20, v212
    v_mov_b32 v21, v213
    v_mov_b32 v22, v214
    v_mov_b32 v23, v215
    s_branch CXE_30
CXW_31:
    s_cmp_lg_u32 s68, 1
    s_cbranch_scc1 CXW_32
    ds_write_b128 v6, v[208:211] offset:4096
    ds_write_b128 v6, v[212:215] offset:5120
    ds_write_b128 v6, v[224:227] offset:0
    ds_write_b128 v6, v[228:231] offset:1024
    ds_write_b128 v6, v[232:235] offset:2048
    ds_write_b128 v6, v[236:239] offset:3072
    v_mov_b32 v16, v216
    v_mov_b32 v17, v217
    v_mov_b32 v18, v218
    v_mov_b32 v19, v219
    v_mov_b32 v20, v220
    v_mov_b32 v21, v221
    v_mov_b32 v22, v222
    v_mov_b32 v23, v223
    s_branch CXE_30
CXW_32:
    s_cmp_lg_u32 s68, 2
    s_cbranch_scc1 CXW_33
    ds_write_b128 v6, v[208:211] offset:2048
    ds_write_b128 v6, v[212:215] offset:3072
    ds_write_b128 v6, v[216:219] offset:4096
    ds_write_b128 v6, v[220:223] offset:5120
    ds_write_b128 v6, v[232:235] offset:0
    ds_write_b128 v6, v[236:239] offset:1024
    v_mov_b32 v16, v224
    v_mov_b32 v17, v225
    v_mov_b32 v18, v226
    v_mov_b32 v19, v227
    v_mov_b32 v20, v228
    v_mov_b32 v21, v229
    v_mov_b32 v22, v230
    v_mov_b32 v23, v231
    s_branch CXE_30
CXW_33:
    s_cmp_lg_u32 s68, 3
    s_cbranch_scc1 CXW_34
    ds_write_b128 v6, v[208:211] offset:0
    ds_write_b128 v6, v[212:215] offset:1024
    ds_write_b128 v6, v[216:219] offset:2048
    ds_write_b128 v6, v[220:223] offset:3072
    ds_write_b128 v6, v[224:227] offset:4096
    ds_write_b128 v6, v[228:231] offset:5120
    v_mov_b32 v16, v232
    v_mov_b32 v17, v233
    v_mov_b32 v18, v234
    v_mov_b32 v19, v235
    v_mov_b32 v20, v236
    v_mov_b32 v21, v237
    v_mov_b32 v22, v238
    v_mov_b32 v23, v239
    s_branch CXE_30
CXW_34:
CXE_30:
    s_waitcnt lgkmcnt(0)
    s_barrier
    s_sub_u32 s64, s68, 1
    s_and_b32 s64, s64, 3
    s_mul_i32 s64, s64, 6144
    s_add_u32 s64, s64, 53248
    v_add_u32 v7, s64, v5
    ds_read_b128 v[24:27], v7 offset:0
    ds_read_b128 v[28:31], v7 offset:1024
    s_sub_u32 s64, s68, 2
    s_and_b32 s64, s64, 3
    s_mul_i32 s64, s64, 6144
    s_add_u32 s64, s64, 53248
    v_add_u32 v7, s64, v5
    ds_read_b128 v[32:35], v7 offset:2048
    ds_read_b128 v[36:39], v7 offset:3072
    s_sub_u32 s64, s68, 3
    s_and_b32 s64, s64, 3
    s_mul_i32 s64, s64, 6144
    s_add_u32 s64, s64, 53248
    v_add_u32 v7, s64, v5
    ds_read_b128 v[40:43], v7 offset:4096
    ds_read_b128 v[44:47], v7 offset:5120
    s_lshl_b32 s64, s68, 10
    v_lshlrev_b32 v8, 5, v1
    v_lshl_add_u32 v8, v2, 3, v8
    v_add_u32 v8, s64, v8
    v_add_u32 v9, s64, v5
    s_lshl_b32 s3, s2, 13
    s_add_u32 s3, s3, 0
    s_add_u32 s3, s3, s64
    v_add_u32 v10, s3, v5
    s_waitcnt lgkmcnt(0)
    v_add_f32 v16, v16, v24
    v_add_f32 v32, v32, v40
    v_add_f32 v16, v16, v32
    v_add_f32 v17, v17, v25
    v_add_f32 v33, v33, v41
    v_add_f32 v17, v17, v33
    v_add_f32 v18, v18, v26
    v_add_f32 v34, v34, v42
    v_add_f32 v18, v18, v34
    v_add_f32 v19, v19, v27
    v_add_f32 v35, v35, v43
    v_add_f32 v19, v19, v35
    v_cvt_pk_bf16_f32 v48, v16, v17
    v_cvt_pk_bf16_f32 v49, v18, v19
    ds_write_b64 v8, v[48:49] offset:0
    v_add_f32 v20, v20, v28
    v_add_f32 v36, v36, v44
    v_add_f32 v20, v20, v36
    v_add_f32 v21, v21, v29
    v_add_f32 v37, v37, v45
    v_add_f32 v21, v21, v37
    v_add_f32 v22, v22, v30
    v_add_f32 v38, v38, v46
    v_add_f32 v22, v22, v38
    v_add_f32 v23, v23, v31
    v_add_f32 v39, v39, v47
    v_add_f32 v23, v23, v39
    v_cvt_pk_bf16_f32 v50, v20, v21
    v_cvt_pk_bf16_f32 v51, v22, v23
    ds_write_b64 v8, v[50:51] offset:512
    s_waitcnt lgkmcnt(0)
    ds_read_b128 v[52:55], v9
    s_waitcnt lgkmcnt(0)
    buffer_store_dwordx4 v[52:55], v10, s[24:27], 0 offen sc1
    s_barrier
    v_lshlrev_b32 v5, 4, v0
    v_add_u32 v10, 4096, v5
    v_add_u32 v6, 1, v1
    v_and_b32 v7, 7, v6
    v_mul_u32_u24 v8, 4352, v7
    s_mov_b32 s67, 3414709264
    v_lshlrev_b32 v9, 2, v7
    v_lshrrev_b32 v9, v9, s67
    v_and_b32 v9, 15, v9
    v_lshl_add_u32 v8, v9, 4, v8
    v_and_b32 v6, 0x18, v6
    v_lshl_add_u32 v6, v2, 3, v6
    v_lshl_add_u32 v8, v6, 1, v8
    s_lshl_b32 s64, s68, 7
    v_add_u32 v11, s64, v8
    v_lshlrev_b32 v6, 5, v1
    v_lshlrev_b32 v7, 4, v2
    v_sub_u32 v6, v7, v6
    s_add_u32 s64, s64, 44512
    v_add_u32 v12, s64, v6
    s_waitcnt vmcnt(1)
    ds_write_b128 v5, v[240:243] offset:0
    v_alignbit_b32 v20, v241, v240, 16
    v_alignbit_b32 v21, v242, v241, 16
    v_alignbit_b32 v22, v243, v242, 16
    v_alignbit_b32 v23, v244, v243, 16
    ds_write_b128 v5, v[20:23] offset:4368
    v_mov_b32 v24, v241
    v_mov_b32 v25, v242
    v_mov_b32 v26, v243
    v_mov_b32 v27, v244
    ds_write_b128 v5, v[24:27] offset:8768
    v_alignbit_b32 v28, v242, v241, 16
    v_alignbit_b32 v29, v243, v242, 16
    v_alignbit_b32 v30, v244, v243, 16
    v_alignbit_b32 v31, v245, v244, 16
    ds_write_b128 v5, v[28:31] offset:13136
    ds_write_b128 v5, v[242:245] offset:17536
    v_alignbit_b32 v36, v243, v242, 16
    v_alignbit_b32 v37, v244, v243, 16
    v_alignbit_b32 v38, v245, v244, 16
    v_alignbit_b32 v39, v246, v245, 16
    ds_write_b128 v5, v[36:39] offset:21888
    v_mov_b32 v40, v243
    v_mov_b32 v41, v244
    v_mov_b32 v42, v245
    v_mov_b32 v43, v246
    ds_write_b128 v5, v[40:43] offset:26288
    v_alignbit_b32 v44, v244, v243, 16
    v_alignbit_b32 v45, v245, v244, 16
    v_alignbit_b32 v46, v246, v245, 16
    v_alignbit_b32 v47, v247, v246, 16
    ds_write_b128 v5, v[44:47] offset:30656
    v_cmp_gt_u32 vcc, 2, v0
    s_nop 0
    s_and_saveexec_b64 s[64:65], vcc
    s_cbranch_execz MK_35
    ds_write_b128 v10, v[248:251] offset:0
    v_alignbit_b32 v20, v249, v248, 16
    v_alignbit_b32 v21, v250, v249, 16
    v_alignbit_b32 v22, v251, v250, 16
    v_alignbit_b32 v23, v252, v251, 16
    ds_write_b128 v10, v[20:23] offset:4368
    v_mov_b32 v24, v249
    v_mov_b32 v25, v250
    v_mov_b32 v26, v251
    v_mov_b32 v27, v252
    ds_write_b128 v10, v[24:27] offset:8768
    v_alignbit_b32 v28, v250, v249, 16
    v_alignbit_b32 v29, v251, v250, 16
    v_alignbit_b32 v30, v252, v251, 16
    v_alignbit_b32 v31, v253, v252, 16
    ds_write_b128 v10, v[28:31] offset:13136
    ds_write_b128 v10, v[250:253] offset:17536
    v_alignbit_b32 v36, v251, v250, 16
    v_alignbit_b32 v37, v252, v251, 16
    v_alignbit_b32 v38, v253, v252, 16
    v_alignbit_b32 v39, v254, v253, 16
    ds_write_b128 v10, v[36:39] offset:21888
    v_mov_b32 v40, v251
    v_mov_b32 v41, v252
    v_mov_b32 v42, v253
    v_mov_b32 v43, v254
    ds_write_b128 v10, v[40:43] offset:26288
    v_alignbit_b32 v44, v252, v251, 16
    v_alignbit_b32 v45, v253, v252, 16
    v_alignbit_b32 v46, v254, v253, 16
    v_alignbit_b32 v47, v255, v254, 16
    ds_write_b128 v10, v[44:47] offset:30656
MK_35:
    s_mov_b64 exec, s[64:65]
    s_waitcnt lgkmcnt(0)
    s_barrier
    v_mov_b32 v208, 0
    v_mov_b32 v209, 0
    v_mov_b32 v210, 0
    v_mov_b32 v211, 0
    v_mov_b32 v212, 0
    v_mov_b32 v213, 0
    v_mov_b32 v214, 0
    v_mov_b32 v215, 0
    v_mov_b32 v216, 0
    v_mov_b32 v217, 0
    v_mov_b32 v218, 0
    v_mov_b32 v219, 0
    v_mov_b32 v220, 0
    v_mov_b32 v221, 0
    v_mov_b32 v222, 0
    v_mov_b32 v223, 0
    v_mov_b32 v224, 0
    v_mov_b32 v225, 0
    v_mov_b32 v226, 0
    v_mov_b32 v227, 0
    v_mov_b32 v228, 0
    v_mov_b32 v229, 0
    v_mov_b32 v230, 0
    v_mov_b32 v231, 0
    v_mov_b32 v232, 0
    v_mov_b32 v233, 0
    v_mov_b32 v234, 0
    v_mov_b32 v235, 0
    v_mov_b32 v236, 0
    v_mov_b32 v237, 0
    v_mov_b32 v238, 0
    v_mov_b32 v239, 0
    ds_read_b128 v[16:19], v11 offset:0
    ds_read_b128 v[48:51], v12 offset:3584
    ds_read_b128 v[80:83], v12 offset:8192
    ds_read_b128 v[20:23], v11 offset:512
    ds_read_b128 v[52:55], v12 offset:3072
    ds_read_b128 v[84:87], v12 offset:7680
    ds_read_b128 v[24:27], v11 offset:1024
    ds_read_b128 v[56:59], v12 offset:2560
    ds_read_b128 v[88:91], v12 offset:7168
    ds_read_b128 v[28:31], v11 offset:1536
    ds_read_b128 v[60:63], v12 offset:2048
    ds_read_b128 v[92:95], v12 offset:6656
    ds_read_b128 v[32:35], v11 offset:2048
    ds_read_b128 v[64:67], v12 offset:1536
    ds_read_b128 v[96:99], v12 offset:6144
    ds_read_b128 v[36:39], v11 offset:2560
    ds_read_b128 v[68:71], v12 offset:1024
    ds_read_b128 v[100:103], v12 offset:5632
    ds_read_b128 v[40:43], v11 offset:3072
    ds_read_b128 v[72:75], v12 offset:512
    ds_read_b128 v[104:107], v12 offset:5120
    ds_read_b128 v[44:47], v11 offset:3584
    ds_read_b128 v[76:79], v12 offset:0
    ds_read_b128 v[108:111], v12 offset:4608
    s_waitcnt lgkmcnt(0)
    v_mfma_f32_16x16x32_bf16 v[208:211], v[16:19], v[48:51], v[208:211]
    v_mfma_f32_16x16x32_bf16 v[208:211], v[16:19], v[80:83], v[208:211]
    v_mfma_f32_16x16x32_bf16 v[212:215], v[16:19], v[52:55], v[212:215]
    v_mfma_f32_16x16x32_bf16 v[212:215], v[16:19], v[84:87], v[212:215]
    v_mfma_f32_16x16x32_bf16 v[212:215], v[20:23], v[48:51], v[212:215]
    v_mfma_f32_16x16x32_bf16 v[212:215], v[20:23], v[80:83], v[212:215]
    v_mfma_f32_16x16x32_bf16 v[216:219], v[16:19], v[56:59], v[216:219]
    v_mfma_f32_16x16x32_bf16 v[216:219], v[16:19], v[88:91], v[216:219]
    v_mfma_f32_16x16x32_bf16 v[216:219], v[20:23], v[52:55], v[216:219]
    v_mfma_f32_16x16x32_bf16 v[216:219], v[20:23], v[84:87], v[216:219]
    ds_read_b128 v[112:115], v11 offset:64
    v_mfma_f32_16x16x32_bf16 v[216:219], v[24:27], v[48:51], v[216:219]
    v_mfma_f32_16x16x32_bf16 v[216:219], v[24:27], v[80:83], v[216:219]
    ds_read_b128 v[144:147], v12 offset:3648
    v_mfma_f32_16x16x32_bf16 v[220:223], v[16:19], v[60:63], v[220:223]
    v_mfma_f32_16x16x32_bf16 v[220:223], v[16:19], v[92:95], v[220:223]
    ds_read_b128 v[176:179], v12 offset:8256
    v_mfma_f32_16x16x32_bf16 v[220:223], v[20:23], v[56:59], v[220:223]
    v_mfma_f32_16x16x32_bf16 v[220:223], v[20:23], v[88:91], v[220:223]
    ds_read_b128 v[116:119], v11 offset:576
    v_mfma_f32_16x16x32_bf16 v[220:223], v[24:27], v[52:55], v[220:223]
    v_mfma_f32_16x16x32_bf16 v[220:223], v[24:27], v[84:87], v[220:223]
    ds_read_b128 v[148:151], v12 offset:3136
    v_mfma_f32_16x16x32_bf16 v[220:223], v[28:31], v[48:51], v[220:223]
    v_mfma_f32_16x16x32_bf16 v[220:223], v[28:31], v[80:83], v[220:223]
    ds_read_b128 v[180:183], v12 offset:7744
    v_mfma_f32_16x16x32_bf16 v[224:227], v[16:19], v[64:67], v[224:227]
    v_mfma_f32_16x16x32_bf16 v[224:227], v[16:19], v[96:99], v[224:227]
    ds_read_b128 v[120:123], v11 offset:1088
    v_mfma_f32_16x16x32_bf16 v[224:227], v[20:23], v[60:63], v[224:227]
    v_mfma_f32_16x16x32_bf16 v[224:227], v[20:23], v[92:95], v[224:227]
    ds_read_b128 v[152:155], v12 offset:2624
    v_mfma_f32_16x16x32_bf16 v[224:227], v[24:27], v[56:59], v[224:227]
    v_mfma_f32_16x16x32_bf16 v[224:227], v[24:27], v[88:91], v[224:227]
    ds_read_b128 v[184:187], v12 offset:7232
    v_mfma_f32_16x16x32_bf16 v[224:227], v[28:31], v[52:55], v[224:227]
    v_mfma_f32_16x16x32_bf16 v[224:227], v[28:31], v[84:87], v[224:227]
    ds_read_b128 v[124:127], v11 offset:1600
    v_mfma_f32_16x16x32_bf16 v[224:227], v[32:35], v[48:51], v[224:227]
    v_mfma_f32_16x16x32_bf16 v[224:227], v[32:35], v[80:83], v[224:227]
    ds_read_b128 v[156:159], v12 offset:2112
    v_mfma_f32_16x16x32_bf16 v[228:231], v[16:19], v[68:71], v[228:231]
    v_mfma_f32_16x16x32_bf16 v[228:231], v[16:19], v[100:103], v[228:231]
    ds_read_b128 v[188:191], v12 offset:6720
    v_mfma_f32_16x16x32_bf16 v[228:231], v[20:23], v[64:67], v[228:231]
    v_mfma_f32_16x16x32_bf16 v[228:231], v[20:23], v[96:99], v[228:231]
    ds_read_b128 v[128:131], v11 offset:2112
    v_mfma_f32_16x16x32_bf16 v[228:231], v[24:27], v[60:63], v[228:231]
    v_mfma_f32_16x16x32_bf16 v[228:231], v[24:27], v[92:95], v[228:231]
    ds_read_b128 v[160:163], v12 offset:1600
    v_mfma_f32_16x16x32_bf16 v[228:231], v[28:31], v[56:59], v[228:231]
    v_mfma_f32_16x16x32_bf16 v[228:231], v[28:31], v[88:91], v[228:231]
    ds_read_b128 v[192:195], v12 offset:6208
    v_mfma_f32_16x16x32_bf16 v[228:231], v[32:35], v[52:55], v[228:231]
    v_mfma_f32_16x16x32_bf16 v[228:231], v[32:35], v[84:87], v[228:231]
    ds_read_b128 v[132:135], v11 offset:2624
    v_mfma_f32_16x16x32_bf16 v[228:231], v[36:39], v[48:51], v[228:231]
    v_mfma_f32_16x16x32_bf16 v[228:231], v[36:39], v[80:83], v[228:231]
    ds_read_b128 v[164:167], v12 offset:1088
    v_mfma_f32_16x16x32_bf16 v[232:235], v[16:19], v[72:75], v[232:235]
    v_mfma_f32_16x16x32_bf16 v[232:235], v[16:19], v[104:107], v[232:235]
    ds_read_b128 v[196:199], v12 offset:5696
    v_mfma_f32_16x16x32_bf16 v[232:235], v[20:23], v[68:71], v[232:235]
    v_mfma_f32_16x16x32_bf16 v[232:235], v[20:23], v[100:103], v[232:235]
    ds_read_b128 v[136:139], v11 offset:3136
    v_mfma_f32_16x16x32_bf16 v[232:235], v[24:27], v[64:67], v[232:235]
    v_mfma_f32_16x16x32_bf16 v[232:235], v[24:27], v[96:99], v[232:235]
    ds_read_b128 v[168:171], v12 offset:576
    v_mfma_f32_16x16x32_bf16 v[232:235], v[28:31], v[60:63], v[232:235]
    v_mfma_f32_16x16x32_bf16 v[232:235], v[28:31], v[92:95], v[232:235]
    ds_read_b128 v[200:203], v12 offset:5184
    v_mfma_f32_16x16x32_bf16 v[232:235], v[32:35], v[56:59], v[232:235]
    v_mfma_f32_16x16x32_bf16 v[232:235], v[32:35], v[88:91], v[232:235]
    ds_read_b128 v[140:143], v11 offset:3648
    v_mfma_f32_16x16x32_bf16 v[232:235], v[36:39], v[52:55], v[232:235]
    v_mfma_f32_16x16x32_bf16 v[232:235], v[36:39], v[84:87], v[232:235]
    ds_read_b128 v[172:175], v12 offset:64
    v_mfma_f32_16x16x32_bf16 v[232:235], v[40:43], v[48:51], v[232:235]
    v_mfma_f32_16x16x32_bf16 v[232:235], v[40:43], v[80:83], v[232:235]
    ds_read_b128 v[204:207], v12 offset:4672
    v_mfma_f32_16x16x32_bf16 v[236:239], v[16:19], v[76:79], v[236:239]
    v_mfma_f32_16x16x32_bf16 v[236:239], v[16:19], v[108:111], v[236:239]
    v_mfma_f32_16x16x32_bf16 v[236:239], v[20:23], v[72:75], v[236:239]
    v_mfma_f32_16x16x32_bf16 v[236:239], v[20:23], v[104:107], v[236:239]
    v_mfma_f32_16x16x32_bf16 v[236:239], v[24:27], v[68:71], v[236:239]
    v_mfma_f32_16x16x32_bf16 v[236:239], v[24:27], v[100:103], v[236:239]
    v_mfma_f32_16x16x32_bf16 v[236:239], v[28:31], v[64:67], v[236:239]
    v_mfma_f32_16x16x32_bf16 v[236:239], v[28:31], v[96:99], v[236:239]
    v_mfma_f32_16x16x32_bf16 v[236:239], v[32:35], v[60:63], v[236:239]
    v_mfma_f32_16x16x32_bf16 v[236:239], v[32:35], v[92:95], v[236:239]
    v_mfma_f32_16x16x32_bf16 v[236:239], v[36:39], v[56:59], v[236:239]
    v_mfma_f32_16x16x32_bf16 v[236:239], v[36:39], v[88:91], v[236:239]
    v_mfma_f32_16x16x32_bf16 v[236:239], v[40:43], v[52:55], v[236:239]
    v_mfma_f32_16x16x32_bf16 v[236:239], v[40:43], v[84:87], v[236:239]
    v_mfma_f32_16x16x32_bf16 v[236:239], v[44:47], v[48:51], v[236:239]
    v_mfma_f32_16x16x32_bf16 v[236:239], v[44:47], v[80:83], v[236:239]
    s_waitcnt lgkmcnt(0)
    v_mfma_f32_16x16x32_bf16 v[208:211], v[112:115], v[144:147], v[208:211]
    v_mfma_f32_16x16x32_bf16 v[208:211], v[112:115], v[176:179], v[208:211]
    v_mfma_f32_16x16x32_bf16 v[212:215], v[112:115], v[148:151], v[212:215]
    v_mfma_f32_16x16x32_bf16 v[212:215], v[112:115], v[180:183], v[212:215]
    v_mfma_f32_16x16x32_bf16 v[212:215], v[116:119], v[144:147], v[212:215]
    v_mfma_f32_16x16x32_bf16 v[212:215], v[116:119], v[176:179], v[212:215]
    v_mfma_f32_16x16x32_bf16 v[216:219], v[112:115], v[152:155], v[216:219]
    v_mfma_f32_16x16x32_bf16 v[216:219], v[112:115], v[184:187], v[216:219]
    v_mfma_f32_16x16x32_bf16 v[216:219], v[116:119], v[148:151], v[216:219]
    v_mfma_f32_16x16x32_bf16 v[216:219], v[116:119], v[180:183], v[216:219]
    v_mfma_f32_16x16x32_bf16 v[216:219], v[120:123], v[144:147], v[216:219]
    v_mfma_f32_16x16x32_bf16 v[216:219], v[120:123], v[176:179], v[216:219]
    v_mfma_f32_16x16x32_bf16 v[220:223], v[112:115], v[156:159], v[220:223]
    v_mfma_f32_16x16x32_bf16 v[220:223], v[112:115], v[188:191], v[220:223]
    v_mfma_f32_16x16x32_bf16 v[220:223], v[116:119], v[152:155], v[220:223]
    v_mfma_f32_16x16x32_bf16 v[220:223], v[116:119], v[184:187], v[220:223]
    v_mfma_f32_16x16x32_bf16 v[220:223], v[120:123], v[148:151], v[220:223]
    v_mfma_f32_16x16x32_bf16 v[220:223], v[120:123], v[180:183], v[220:223]
    v_mfma_f32_16x16x32_bf16 v[220:223], v[124:127], v[144:147], v[220:223]
    v_mfma_f32_16x16x32_bf16 v[220:223], v[124:127], v[176:179], v[220:223]
    v_mfma_f32_16x16x32_bf16 v[224:227], v[112:115], v[160:163], v[224:227]
    v_mfma_f32_16x16x32_bf16 v[224:227], v[112:115], v[192:195], v[224:227]
    v_mfma_f32_16x16x32_bf16 v[224:227], v[116:119], v[156:159], v[224:227]
    v_mfma_f32_16x16x32_bf16 v[224:227], v[116:119], v[188:191], v[224:227]
    v_mfma_f32_16x16x32_bf16 v[224:227], v[120:123], v[152:155], v[224:227]
    v_mfma_f32_16x16x32_bf16 v[224:227], v[120:123], v[184:187], v[224:227]
    v_mfma_f32_16x16x32_bf16 v[224:227], v[124:127], v[148:151], v[224:227]
    v_mfma_f32_16x16x32_bf16 v[224:227], v[124:127], v[180:183], v[224:227]
    v_mfma_f32_16x16x32_bf16 v[224:227], v[128:131], v[144:147], v[224:227]
    v_mfma_f32_16x16x32_bf16 v[224:227], v[128:131], v[176:179], v[224:227]
    v_mfma_f32_16x16x32_bf16 v[228:231], v[112:115], v[164:167], v[228:231]
    v_mfma_f32_16x16x32_bf16 v[228:231], v[112:115], v[196:199], v[228:231]
    v_mfma_f32_16x16x32_bf16 v[228:231], v[116:119], v[160:163], v[228:231]
    v_mfma_f32_16x16x32_bf16 v[228:231], v[116:119], v[192:195], v[228:231]
    v_mfma_f32_16x16x32_bf16 v[228:231], v[120:123], v[156:159], v[228:231]
    v_mfma_f32_16x16x32_bf16 v[228:231], v[120:123], v[188:191], v[228:231]
    v_mfma_f32_16x16x32_bf16 v[228:231], v[124:127], v[152:155], v[228:231]
    v_mfma_f32_16x16x32_bf16 v[228:231], v[124:127], v[184:187], v[228:231]
    v_mfma_f32_16x16x32_bf16 v[228:231], v[128:131], v[148:151], v[228:231]
    v_mfma_f32_16x16x32_bf16 v[228:231], v[128:131], v[180:183], v[228:231]
    v_mfma_f32_16x16x32_bf16 v[228:231], v[132:135], v[144:147], v[228:231]
    v_mfma_f32_16x16x32_bf16 v[228:231], v[132:135], v[176:179], v[228:231]
    v_mfma_f32_16x16x32_bf16 v[232:235], v[112:115], v[168:171], v[232:235]
    v_mfma_f32_16x16x32_bf16 v[232:235], v[112:115], v[200:203], v[232:235]
    v_mfma_f32_16x16x32_bf16 v[232:235], v[116:119], v[164:167], v[232:235]
    v_mfma_f32_16x16x32_bf16 v[232:235], v[116:119], v[196:199], v[232:235]
    v_mfma_f32_16x16x32_bf16 v[232:235], v[120:123], v[160:163], v[232:235]
    v_mfma_f32_16x16x32_bf16 v[232:235], v[120:123], v[192:195], v[232:235]
    v_mfma_f32_16x16x32_bf16 v[232:235], v[124:127], v[156:159], v[232:235]
    v_mfma_f32_16x16x32_bf16 v[232:235], v[124:127], v[188:191], v[232:235]
    v_mfma_f32_16x16x32_bf16 v[232:235], v[128:131], v[152:155], v[232:235]
    v_mfma_f32_16x16x32_bf16 v[232:235], v[128:131], v[184:187], v[232:235]
    v_mfma_f32_16x16x32_bf16 v[232:235], v[132:135], v[148:151], v[232:235]
    v_mfma_f32_16x16x32_bf16 v[232:235], v[132:135], v[180:183], v[232:235]
    v_mfma_f32_16x16x32_bf16 v[232:235], v[136:139], v[144:147], v[232:235]
    v_mfma_f32_16x16x32_bf16 v[232:235], v[136:139], v[176:179], v[232:235]
    v_mfma_f32_16x16x32_bf16 v[236:239], v[112:115], v[172:175], v[236:239]
    v_mfma_f32_16x16x32_bf16 v[236:239], v[112:115], v[204:207], v[236:239]
    v_mfma_f32_16x16x32_bf16 v[236:239], v[116:119], v[168:171], v[236:239]
    v_mfma_f32_16x16x32_bf16 v[236:239], v[116:119], v[200:203], v[236:239]
    v_mfma_f32_16x16x32_bf16 v[236:239], v[120:123], v[164:167], v[236:239]
    v_mfma_f32_16x16x32_bf16 v[236:239], v[120:123], v[196:199], v[236:239]
    v_mfma_f32_16x16x32_bf16 v[236:239], v[124:127], v[160:163], v[236:239]
    v_mfma_f32_16x16x32_bf16 v[236:239], v[124:127], v[192:195], v[236:239]
    v_mfma_f32_16x16x32_bf16 v[236:239], v[128:131], v[156:159], v[236:239]
    v_mfma_f32_16x16x32_bf16 v[236:239], v[128:131], v[188:191], v[236:239]
    v_mfma_f32_16x16x32_bf16 v[236:239], v[132:135], v[152:155], v[236:239]
    v_mfma_f32_16x16x32_bf16 v[236:239], v[132:135], v[184:187], v[236:239]
    v_mfma_f32_16x16x32_bf16 v[236:239], v[136:139], v[148:151], v[236:239]
    v_mfma_f32_16x16x32_bf16 v[236:239], v[136:139], v[180:183], v[236:239]
    v_mfma_f32_16x16x32_bf16 v[236:239], v[140:143], v[144:147], v[236:239]
    v_mfma_f32_16x16x32_bf16 v[236:239], v[140:143], v[176:179], v[236:239]
    v_lshlrev_b32 v5, 4, v4
    s_mul_i32 s64, s68, 6144
    s_add_u32 s64, s64, 53248
    v_add_u32 v6, s64, v5
    s_nop 7
    s_cmp_lg_u32 s68, 0
    s_cbranch_scc1 CXW_37
    ds_write_b128 v6, v[216:219] offset:0
    ds_write_b128 v6, v[220:223] offset:1024
    ds_write_b128 v6, v[224:227] offset:2048
    ds_write_b128 v6, v[228:231] offset:3072
    ds_write_b128 v6, v[232:235] offset:4096
    ds_write_b128 v6, v[236:239] offset:5120
    v_mov_b32 v16, v208
    v_mov_b32 v17, v209
    v_mov_b32 v18, v210
    v_mov_b32 v19, v211
    v_mov_b32 v20, v212
    v_mov_b32 v21, v213
    v_mov_b32 v22, v214
    v_mov_b32 v23, v215
    s_branch CXE_36
CXW_37:
    s_cmp_lg_u32 s68, 1
    s_cbranch_scc1 CXW_38
    ds_write_b128 v6, v[208:211] offset:4096
    ds_write_b128 v6, v[212:215] offset:5120
    ds_write_b128 v6, v[224:227] offset:0
    ds_write_b128 v6, v[228:231] offset:1024
    ds_write_b128 v6, v[232:235] offset:2048
    ds_write_b128 v6, v[236:239] offset:3072
    v_mov_b32 v16, v216
    v_mov_b32 v17, v217
    v_mov_b32 v18, v218
    v_mov_b32 v19, v219
    v_mov_b32 v20, v220
    v_mov_b32 v21, v221
    v_mov_b32 v22, v222
    v_mov_b32 v23, v223
    s_branch CXE_36
CXW_38:
    s_cmp_lg_u32 s68, 2
    s_cbranch_scc1 CXW_39
    ds_write_b128 v6, v[208:211] offset:2048
    ds_write_b128 v6, v[212:215] offset:3072
    ds_write_b128 v6, v[216:219] offset:4096
    ds_write_b128 v6, v[220:223] offset:5120
    ds_write_b128 v6, v[232:235] offset:0
    ds_write_b128 v6, v[236:239] offset:1024
    v_mov_b32 v16, v224
    v_mov_b32 v17, v225
    v_mov_b32 v18, v226
    v_mov_b32 v19, v227
    v_mov_b32 v20, v228
    v_mov_b32 v21, v229
    v_mov_b32 v22, v230
    v_mov_b32 v23, v231
    s_branch CXE_36
CXW_39:
    s_cmp_lg_u32 s68, 3
    s_cbranch_scc1 CXW_40
    ds_write_b128 v6, v[208:211] offset:0
    ds_write_b128 v6, v[212:215] offset:1024
    ds_write_b128 v6, v[216:219] offset:2048
    ds_write_b128 v6, v[220:223] offset:3072
    ds_write_b128 v6, v[224:227] offset:4096
    ds_write_b128 v6, v[228:231] offset:5120
    v_mov_b32 v16, v232
    v_mov_b32 v17, v233
    v_mov_b32 v18, v234
    v_mov_b32 v19, v235
    v_mov_b32 v20, v236
    v_mov_b32 v21, v237
    v_mov_b32 v22, v238
    v_mov_b32 v23, v239
    s_branch CXE_36
CXW_40:
CXE_36:
    s_waitcnt lgkmcnt(0)
    s_barrier
    s_sub_u32 s64, s68, 1
    s_and_b32 s64, s64, 3
    s_mul_i32 s64, s64, 6144
    s_add_u32 s64, s64, 53248
    v_add_u32 v7, s64, v5
    ds_read_b128 v[24:27], v7 offset:0
    ds_read_b128 v[28:31], v7 offset:1024
    s_sub_u32 s64, s68, 2
    s_and_b32 s64, s64, 3
    s_mul_i32 s64, s64, 6144
    s_add_u32 s64, s64, 53248
    v_add_u32 v7, s64, v5
    ds_read_b128 v[32:35], v7 offset:2048
    ds_read_b128 v[36:39], v7 offset:3072
    s_sub_u32 s64, s68, 3
    s_and_b32 s64, s64, 3
    s_mul_i32 s64, s64, 6144
    s_add_u32 s64, s64, 53248
    v_add_u32 v7, s64, v5
    ds_read_b128 v[40:43], v7 offset:4096
    ds_read_b128 v[44:47], v7 offset:5120
    s_lshl_b32 s64, s68, 10
    v_lshlrev_b32 v8, 5, v1
    v_lshl_add_u32 v8, v2, 3, v8
    v_add_u32 v8, s64, v8
    v_add_u32 v9, s64, v5
    s_lshl_b32 s3, s2, 13
    s_add_u32 s3, s3, 4096
    s_add_u32 s3, s3, s64
    v_add_u32 v10, s3, v5
    s_waitcnt lgkmcnt(0)
    v_add_f32 v16, v16, v24
    v_add_f32 v32, v32, v40
    v_add_f32 v16, v16, v32
    v_add_f32 v17, v17, v25
    v_add_f32 v33, v33, v41
    v_add_f32 v17, v17, v33
    v_add_f32 v18, v18, v26
    v_add_f32 v34, v34, v42
    v_add_f32 v18, v18, v34
    v_add_f32 v19, v19, v27
    v_add_f32 v35, v35, v43
    v_add_f32 v19, v19, v35
    v_cvt_pk_bf16_f32 v48, v16, v17
    v_cvt_pk_bf16_f32 v49, v18, v19
    ds_write_b64 v8, v[48:49] offset:0
    v_add_f32 v20, v20, v28
    v_add_f32 v36, v36, v44
    v_add_f32 v20, v20, v36
    v_add_f32 v21, v21, v29
    v_add_f32 v37, v37, v45
    v_add_f32 v21, v21, v37
    v_add_f32 v22, v22, v30
    v_add_f32 v38, v38, v46
    v_add_f32 v22, v22, v38
    v_add_f32 v23, v23, v31
    v_add_f32 v39, v39, v47
    v_add_f32 v23, v23, v39
    v_cvt_pk_bf16_f32 v50, v20, v21
    v_cvt_pk_bf16_f32 v51, v22, v23
    ds_write_b64 v8, v[50:51] offset:512
    s_waitcnt lgkmcnt(0)
    ds_read_b128 v[52:55], v9
    s_waitcnt lgkmcnt(0)
    buffer_store_dwordx4 v[52:55], v10, s[24:27], 0 offen sc1
    s_barrier
    s_waitcnt vmcnt(0)
    s_barrier
    v_mov_b32 v5, s83
    s_lshl_b32 s64, s2, 2
    s_add_u32 s64, s64, 16384
    v_lshlrev_b32 v6, 10, v0
    v_add_u32 v6, s64, v6
    v_cmp_gt_u32 vcc, 8, v0
    s_nop 0
    s_and_saveexec_b64 s[64:65], vcc
    s_cbranch_execz MK_41
    buffer_store_dword v5, v6, s[4:7], 0 offen sc1
MK_41:
    s_mov_b64 exec, s[64:65]
K_END:
    s_endpgm
.section .rodata,"a"
.p2align 6
.amdhsa_kernel parallel_sum__ssm_conv_s4d__swiglu_ffn__prompt_kernel
  .amdhsa_next_free_vgpr 256
  .amdhsa_next_free_sgpr 102
  .amdhsa_accum_offset 256
  .amdhsa_group_segment_fixed_size 0
  .amdhsa_kernarg_size 112
  .amdhsa_user_sgpr_count 2
  .amdhsa_user_sgpr_kernarg_segment_ptr 1
  .amdhsa_system_sgpr_workgroup_id_x 1
.end_amdhsa_kernel
```
